```python
import torch

def _softmax(x, axis=-1):
    return torch.softmax(x, dim=axis)
def _gelu(x):
    return torch.nn.functional.gelu(x, approximate="tanh")
def _silu(x):
    return torch.nn.functional.silu(x)
def _sigmoid(x):
    return torch.sigmoid(x)
def _layernorm(x, axis=-1, eps=1e-5):
    m = x.mean(dim=axis, keepdim=True)
    v = x.var(dim=axis, keepdim=True, unbiased=False)
    return (x - m) / torch.sqrt(v + eps)
def _scatter_add(tgt, idx, src, axis=0):
    return tgt.clone().index_add_(axis, idx, src)
def _segment_sum(src, seg, n):
    out = torch.zeros((n,) + src.shape[1:], dtype=src.dtype)
    return out.index_add_(0, seg, src)
def _pad(x, pw):
    flat = tuple(v for pair in reversed(pw) for v in pair)
    return torch.nn.functional.pad(x, flat)

kernel_name = 'standalone__gqa_block_cached__near_ridge'

def setup_inputs():

    _w = (lambda a: (lambda t: t.to(torch.bfloat16) if t.is_floating_point() else t)(torch.as_tensor(a)))
    B, Sq, D = 8, 96, 576
    Hq, Hkv, Sk, Dh = 32, 16, 512, 128
    assert Hq % Hkv == 0, (Hq, Hkv)
    return {
        "x": _w((lambda *s: torch.randn(*s, dtype=torch.bfloat16) * 0.8)(B, Sq, D)),
        "k_cache": _w((lambda *s: torch.randn(*s, dtype=torch.bfloat16) * 0.8)(B, Hkv, Sk, Dh)),
        "v_cache": _w((lambda *s: torch.randn(*s, dtype=torch.bfloat16) * 0.05)(B, Hkv, Sk, Dh)),
        "wq": _w((lambda *s: torch.randn(*s, dtype=torch.bfloat16) * 0.8)(D, Hq * Dh) * (D ** -0.5)),
        "wo": _w((lambda *s: torch.randn(*s, dtype=torch.bfloat16) * 0.05)(Hq * Dh, D) * ((Hq * Dh) ** -0.5)),
    }

def reference(x, k_cache, v_cache, wq, wo):
    B, Sq, D = x.shape
    Hq, Dh = 32, 128
    Hkv = k_cache.shape[1]
    rep = Hq // Hkv
    q = (lambda x, *d: x.permute(*d))((x @ wq).reshape(B, Sq, Hq, Dh), 0, 2, 1, 3)
    k = (lambda x, n, axis: torch.repeat_interleave(x, n, dim=axis))(k_cache, rep, axis=1)
    v = (lambda x, n, axis: torch.repeat_interleave(x, n, dim=axis))(v_cache, rep, axis=1)
    scores = torch.einsum("bhqd,bhkd->bhqk", q, k) * (Dh ** -0.5)
    p = _softmax(scores, axis=-1)
    o = torch.einsum("bhqk,bhkd->bhqd", p, v)
    return (lambda x, *d: x.permute(*d))(o, 0, 2, 1, 3).reshape(B, Sq, Hq * Dh) @ wo
```

```asm
; @launch grid=(256,1,1) block=(256,1,1) lds=163840
.amdgcn_target "amdgcn-amd-amdhsa--gfx950"
.text
.globl standalone__gqa_block_cached__near_ridge_kernel
.p2align 8
.type standalone__gqa_block_cached__near_ridge_kernel,@function
standalone__gqa_block_cached__near_ridge_kernel:
s_cmp_ge_u32 s2, 256
s_cbranch_scc1 K1_EXIT
s_load_dwordx8 s[4:11], s[0:1], 0
s_load_dwordx4 s[12:15], s[0:1], 32
s_load_dwordx2 s[32:33], s[0:1], 56
s_getpc_b64 s[92:93]
s_bfe_u32 s39, s2, 0x30003
v_lshrrev_b32 v62, 3, v0
s_mul_i32 s39, s39, 3072
v_mul_u32_u24 v62, 96, v62
s_add_u32 s92, s92, s39
s_addc_u32 s93, s93, 0
global_load_dword v63, v62, s[92:93]
v_lshrrev_b32 v48, 6, v0
v_and_b32 v0, 63, v0
v_readfirstlane_b32 s36, v48
s_lshr_b32 s37, s2, 4
v_lshrrev_b32 v48, 4, v0
s_mul_i32 s40, s37, 55296
s_and_b32 s39, s36, 1
s_lshl_b32 s39, s39, 2
v_add_u32 v49, s39, v48
v_xor_b32 v49, v49, v0
v_lshlrev_b32 v55, 4, v49
s_lshl_b32 s51, s36, 10
s_add_u32 s40, s40, s51
s_and_b32 s59, s36, 2
s_lshl_b32 s59, s59, 10
s_mov_b32 s18, 884736
s_mov_b32 s19, 0x20000
s_add_u32 m0, s51, 65536
s_waitcnt lgkmcnt(0)
s_mov_b32 s16, s4
s_and_b32 s17, s5, 0xffff
buffer_load_dwordx4 v55, s[16:19], s40 offen offset:0 lds
s_add_u32 m0, s51, 69632
s_add_u32 s40, s40, 4096
s_and_b32 s38, s2, 7
s_lshl_b32 s38, s38, 1
s_bfe_u32 s39, s2, 0x10003
s_add_u32 s38, s38, s39
s_cmp_ge_u32 s37, 9
s_cselect_b32 s39, 9, 0
buffer_load_dwordx4 v55, s[16:19], s40 offen offset:0 lds
s_add_u32 m0, s51, 73728
s_add_u32 s40, s40, 4096
s_sub_u32 s52, s37, s39
s_mov_b32 s28, s10
s_and_b32 s29, s11, 0xffff
s_mov_b32 s30, 4718592
s_mov_b32 s31, 0x20000
s_mov_b32 s20, s6
buffer_load_dwordx4 v55, s[16:19], s40 offen offset:0 lds
s_add_u32 m0, s51, 77824
s_add_u32 s40, s40, 4096
s_and_b32 s21, s7, 0xffff
s_mov_b32 s22, 16777216
s_mov_b32 s23, 0x20000
s_mov_b32 s24, s8
s_and_b32 s25, s9, 0xffff
s_mov_b32 s26, 16777216
buffer_load_dwordx4 v55, s[16:19], s40 offen offset:0 lds
s_add_u32 m0, s51, 81920
s_add_u32 s40, s40, 4096
s_mov_b32 s27, 0x20000
s_and_b32 s33, s33, 0xffff
s_mov_b32 s34, 268435456
s_mov_b32 s35, 0x20000
s_mov_b32 s96, s12
s_and_b32 s97, s13, 0xffff
buffer_load_dwordx4 v55, s[16:19], s40 offen offset:0 lds
s_add_u32 m0, s51, 86016
s_add_u32 s40, s40, 4096
s_mov_b32 s98, 4718592
s_mov_b32 s99, 0x20000
v_lshrrev_b32 v50, 3, v0
v_and_b32 v51, 7, v0
v_lshlrev_b32 v51, 4, v51
v_lshlrev_b32 v52, 1, v0
v_and_b32 v53, 32, v52
buffer_load_dwordx4 v55, s[16:19], s40 offen offset:0 lds
s_add_u32 m0, s51, 90112
s_add_u32 s40, s40, 4096
v_xor_b32 v53, v53, v51
v_lshl_add_u32 v40, v50, 13, v53
v_add_u32 v41, 64512, v40
v_add_u32 v42, 129024, v40
v_add_u32 v43, 193536, v40
v_xor_b32 v44, 64, v40
buffer_load_dwordx4 v55, s[16:19], s40 offen offset:0 lds
s_add_u32 m0, s51, 94208
s_add_u32 s40, s40, 4096
v_add_u32 v44, 262144, v44
v_add_u32 v45, 64512, v44
v_add_u32 v46, 129024, v44
v_add_u32 v47, 193536, v44
s_lshl_b32 s58, s38, 9
s_lshl_b32 s39, s36, 7
buffer_load_dwordx4 v55, s[16:19], s40 offen offset:0 lds
s_add_u32 m0, s51, 98304
s_add_u32 s40, s40, 4096
s_add_u32 s58, s58, s39
s_lshl_b32 s54, s36, 13
s_lshl_b32 s56, s38, 2
s_add_u32 s56, s56, s36
s_mul_i32 s56, s56, 73728
v_and_b32 v53, 96, v52
buffer_load_dwordx4 v55, s[16:19], s40 offen offset:0 lds
s_add_u32 m0, s51, 102400
s_add_u32 s40, s40, 4096
v_xor_b32 v53, v53, v51
v_mul_u32_u24 v50, 1152, v50
v_add_u32 v1, v50, v53
v_add_u32 v2, 8192, v1
v_add_u32 v3, 16384, v1
v_add_u32 v4, 24576, v1
buffer_load_dwordx4 v55, s[16:19], s40 offen offset:0 lds
s_add_u32 m0, s51, 106496
s_add_u32 s40, s40, 4096
v_and_b32 v49, 15, v0
v_lshrrev_b32 v50, 1, v0
v_and_b32 v50, 4, v50
v_xor_b32 v50, v50, v49
v_mul_u32_u24 v50, 72, v50
v_add_u32 v38, 4096, v50
v_lshrrev_b32 v50, 5, v0
buffer_load_dwordx4 v55, s[16:19], s40 offen offset:0 lds
s_add_u32 m0, s51, 110592
s_add_u32 s40, s40, 4096
v_and_b32 v53, 16, v0
v_lshlrev_b32 v51, 4, v50
v_lshl_add_u32 v39, v53, 2, v51
s_mov_b32 s42, s52
s_lshl_b32 s39, s42, 19
s_add_u32 s41, s39, s58
buffer_load_dwordx4 v55, s[16:19], s40 offen offset:0 lds
s_add_u32 m0, s51, 114688
s_add_u32 s40, s40, 4096
s_lshl_b32 s39, s42, 7
s_add_u32 s83, s39, s56
v_lshl_add_u32 v208, s42, 3, v38
v_and_b32 v209, 0x70, v208
v_xor_b32 v209, v209, v39
v_lshl_add_u32 v208, v208, 4, v209
buffer_load_dwordx4 v55, s[16:19], s40 offen offset:0 lds
s_sub_u32 s51, s51, s59
s_sub_u32 s40, s40, s59
s_add_u32 m0, s51, 118784
s_add_u32 s40, s40, 4096
v_xor_b32 v209, 32, v208
s_add_u32 s42, s42, 1
s_cmp_eq_u32 s42, 9
s_cselect_b32 s42, 0, s42
s_lshl_b32 s39, s42, 19
s_add_u32 s5, s39, s58
buffer_load_dwordx4 v55, s[16:19], s40 offen offset:0 lds
s_lshl_b32 s39, s42, 7
s_add_u32 s84, s39, s56
v_lshl_add_u32 v210, s42, 3, v38
v_and_b32 v211, 0x70, v210
v_xor_b32 v211, v211, v39
v_lshl_add_u32 v210, v210, 4, v211
v_xor_b32 v211, 32, v210
s_add_u32 m0, s54, 32768
s_nop 0
buffer_load_dwordx4 v40, s[28:31], s41 offen offset:0 lds
buffer_load_dwordx4 v41, s[28:31], s41 offen offset:1024 lds
s_lshl_b32 s3, s37, 12
s_add_u32 s3, s3, 4194304
s_add_u32 s42, s42, 1
s_cmp_eq_u32 s42, 9
s_cselect_b32 s42, 0, s42
s_lshl_b32 s39, s42, 19
s_add_u32 s6, s39, s58
s_lshl_b32 s39, s42, 7
s_add_u32 s85, s39, s56
v_lshl_add_u32 v212, s42, 3, v38
v_and_b32 v213, 0x70, v212
v_xor_b32 v213, v213, v39
v_lshl_add_u32 v212, v212, 4, v213
v_xor_b32 v213, 32, v212
s_add_u32 s42, s42, 1
s_cmp_eq_u32 s42, 9
s_cselect_b32 s42, 0, s42
s_lshl_b32 s39, s42, 19
s_add_u32 s7, s39, s58
s_lshl_b32 s39, s42, 7
s_add_u32 s86, s39, s56
v_lshl_add_u32 v214, s42, 3, v38
v_and_b32 v215, 0x70, v214
v_xor_b32 v215, v215, v39
v_lshl_add_u32 v214, v214, 4, v215
v_xor_b32 v215, 32, v214
s_add_u32 s42, s42, 1
s_cmp_eq_u32 s42, 9
s_cselect_b32 s42, 0, s42
s_lshl_b32 s39, s42, 19
s_add_u32 s8, s39, s58
s_lshl_b32 s39, s42, 7
s_add_u32 s87, s39, s56
v_lshl_add_u32 v216, s42, 3, v38
v_and_b32 v217, 0x70, v216
v_xor_b32 v217, v217, v39
v_lshl_add_u32 v216, v216, 4, v217
v_xor_b32 v217, 32, v216
s_add_u32 s42, s42, 1
s_cmp_eq_u32 s42, 9
s_cselect_b32 s42, 0, s42
s_lshl_b32 s39, s42, 19
s_add_u32 s9, s39, s58
s_lshl_b32 s39, s42, 7
s_add_u32 s88, s39, s56
v_lshl_add_u32 v218, s42, 3, v38
v_and_b32 v219, 0x70, v218
v_xor_b32 v219, v219, v39
v_lshl_add_u32 v218, v218, 4, v219
v_xor_b32 v219, 32, v218
s_add_u32 s42, s42, 1
s_cmp_eq_u32 s42, 9
s_cselect_b32 s42, 0, s42
s_lshl_b32 s39, s42, 19
s_add_u32 s10, s39, s58
s_lshl_b32 s39, s42, 7
s_add_u32 s89, s39, s56
v_lshl_add_u32 v220, s42, 3, v38
v_and_b32 v221, 0x70, v220
v_xor_b32 v221, v221, v39
v_lshl_add_u32 v220, v220, 4, v221
v_xor_b32 v221, 32, v220
s_add_u32 s42, s42, 1
s_cmp_eq_u32 s42, 9
s_cselect_b32 s42, 0, s42
s_lshl_b32 s39, s42, 19
s_add_u32 s11, s39, s58
s_lshl_b32 s39, s42, 7
s_add_u32 s90, s39, s56
v_lshl_add_u32 v222, s42, 3, v38
v_and_b32 v223, 0x70, v222
v_xor_b32 v223, v223, v39
v_lshl_add_u32 v222, v222, 4, v223
v_xor_b32 v223, 32, v222
s_add_u32 s42, s42, 1
s_cmp_eq_u32 s42, 9
s_cselect_b32 s42, 0, s42
s_lshl_b32 s39, s42, 19
s_add_u32 s12, s39, s58
s_lshl_b32 s39, s42, 7
s_add_u32 s91, s39, s56
v_lshl_add_u32 v224, s42, 3, v38
v_and_b32 v225, 0x70, v224
v_xor_b32 v225, v225, v39
v_lshl_add_u32 v224, v224, 4, v225
v_xor_b32 v225, 32, v224
s_lshr_b32 s58, s37, 1
s_lshl_b32 s58, s58, 4
s_add_u32 s39, s38, s58
s_lshl_b32 s39, s39, 17
s_lshl_b32 s58, s36, 15
s_add_u32 s39, s39, s58
s_add_u32 s43, s39, 0
s_add_u32 s44, s39, 4096
s_add_u32 s45, s39, 8192
s_add_u32 s46, s39, 12288
s_add_u32 s47, s39, 16384
s_add_u32 s48, s39, 20480
s_add_u32 s49, s39, 24576
s_add_u32 s50, s39, 28672
s_add_u32 s53, s54, 98304
v_lshlrev_b32 v49, 4, v49
v_lshl_add_u32 v49, v50, 8, v49
v_add_u32 v49, 131072, v49
v_lshrrev_b32 v51, 1, v53
v_add3_u32 v35, v49, v51, s54
v_lshl_add_u32 v36, v53, 7, v49
v_mul_u32_u24 v51, 768, v53
v_add_u32 v37, v51, v49
v_lshl_add_u32 v8, v53, 6, v49
v_add_u32 v8, s54, v8
v_lshlrev_b32 v49, 2, v48
v_xor_b32 v49, v49, v0
v_and_b32 v49, 15, v49
v_lshlrev_b32 v49, 4, v49
v_lshl_add_u32 v13, v48, 8, v49
v_xor_b32 v49, v48, v0
v_and_b32 v49, 15, v49
v_lshlrev_b32 v49, 4, v49
v_lshl_add_u32 v9, v48, 8, v49
v_xor_b32 v10, 64, v9
v_xor_b32 v11, 128, v9
v_xor_b32 v12, 192, v9
v_and_b32 v51, 31, v0
v_and_b32 v49, 15, v0
v_xor_b32 v49, v49, v50
v_lshlrev_b32 v49, 4, v49
v_lshl_add_u32 v49, v51, 8, v49
s_add_u32 s39, s54, 65536
v_add_u32 v18, s39, v49
v_xor_b32 v19, 32, v18
v_xor_b32 v20, 64, v18
v_xor_b32 v21, 96, v18
v_xor_b32 v22, 128, v18
v_xor_b32 v23, 160, v18
v_xor_b32 v24, 192, v18
v_xor_b32 v25, 224, v18
v_bfe_u32 v49, v0, 2, 2
v_and_b32 v51, 3, v0
v_lshlrev_b32 v51, 3, v51
v_bfe_u32 v52, v0, 3, 2
v_lshl_add_u32 v14, v52, 5, v51
v_lshl_add_u32 v14, v49, 7, v14
v_lshl_add_u32 v14, v50, 10, v14
v_lshl_add_u32 v14, v53, 8, v14
v_add_u32 v14, s54, v14
v_xor_b32 v15, 32, v14
v_xor_b32 v16, 64, v14
v_xor_b32 v17, 96, v14
v_xor_b32 v52, s36, v52
v_lshl_add_u32 v5, v52, 5, v51
v_lshl_add_u32 v5, v49, 7, v5
v_lshl_add_u32 v5, v50, 11, v5
v_lshl_add_u32 v5, v53, 5, v5
v_add_u32 v6, 0x10000, v5
v_add_u32 v7, 0x20000, v5
v_xor_b32 v52, s36, v49
v_lshlrev_b32 v52, 6, v52
v_lshl_add_u32 v52, v49, 8, v52
v_lshl_add_u32 v52, v53, 1, v52
v_add_u32 v52, v52, v51
v_lshl_add_u32 v52, v50, 10, v52
v_lshlrev_b32 v53, 4, v0
v_add_u32 v26, 98304, v53
v_add_u32 v27, s53, v53
s_add_u32 s39, s36, 0
s_and_b32 s39, s39, 3
s_lshl_b32 s58, s39, 13
v_add_u32 v31, s58, v52
s_add_u32 s39, s36, 1
s_and_b32 s39, s39, 3
s_lshl_b32 s58, s39, 13
v_add_u32 v32, s58, v52
v_add_u32 v28, s58, v26
s_add_u32 s39, s36, 2
s_and_b32 s39, s39, 3
s_lshl_b32 s58, s39, 13
v_add_u32 v33, s58, v52
v_add_u32 v29, s58, v26
s_add_u32 s39, s36, 3
s_and_b32 s39, s39, 3
s_lshl_b32 s58, s39, 13
v_add_u32 v34, s58, v52
v_add_u32 v30, s58, v26
s_lshl_b32 s39, s37, 4
s_add_u32 s39, s39, s38
s_mul_i32 s39, s39, 69888
s_lshl_b32 s58, s36, 12
s_add_u32 s39, s39, s58
s_add_u32 s55, s39, 8388608
s_add_u32 s40, s39, 8404992
s_add_u32 s51, s39, 8421376
s_add_u32 s59, s39, 8437760
v_mov_b32 v56, 0x3e0293ee
buffer_load_dwordx4 v42, s[28:31], s41 offen offset:2048 lds
buffer_load_dwordx4 v43, s[28:31], s41 offen offset:3072 lds
s_add_u32 m0, s54, 36864
s_nop 0
buffer_load_dwordx4 v44, s[28:31], s41 offen offset:0 lds
buffer_load_dwordx4 v45, s[28:31], s41 offen offset:1024 lds
buffer_load_dwordx4 v46, s[28:31], s41 offen offset:2048 lds
buffer_load_dwordx4 v47, s[28:31], s41 offen offset:3072 lds
buffer_load_dword v54, off, s[32:35], s3 offset:2048 sc1
s_add_u32 m0, s54, 0
s_nop 0
buffer_load_dwordx4 v40, s[28:31], s5 offen offset:0 lds
buffer_load_dwordx4 v41, s[28:31], s5 offen offset:1024 lds
buffer_load_dwordx4 v42, s[28:31], s5 offen offset:2048 lds
buffer_load_dwordx4 v43, s[28:31], s5 offen offset:3072 lds
s_add_u32 m0, s54, 4096
s_nop 0
buffer_load_dwordx4 v44, s[28:31], s5 offen offset:0 lds
buffer_load_dwordx4 v45, s[28:31], s5 offen offset:1024 lds
buffer_load_dwordx4 v46, s[28:31], s5 offen offset:2048 lds
buffer_load_dwordx4 v47, s[28:31], s5 offen offset:3072 lds
s_add_u32 s1, s38, s37
s_and_b32 s1, s1, 15
s_mul_i32 s41, s37, 1118208
s_lshl4_add_u32 s39, s36, s1
s_lshl_b32 s39, s39, 8
s_add_u32 s41, s41, s39
s_add_u32 s41, s41, 8388608
s_add_u32 s42, s41, 16384
s_add_u32 s53, s41, 32768
s_add_u32 s56, s41, 49152
s_bfe_u32 s39, s1, 0x10001
s_xor_b32 s39, s39, s1
s_and_b32 s39, s39, 3
s_mul_i32 s39, s39, 4608
s_mul_i32 s82, s37, 55296
s_add_u32 s82, s82, s39
s_lshl_b32 s39, s36, 5
s_add_u32 s82, s82, s39
s_lshr_b32 s39, s1, 2
s_mul_i32 s58, s39, 18432
s_lshl_b32 s0, s52, 7
s_cmp_eq_u32 s39, 3
s_cselect_b32 s58, s0, s58
s_add_u32 s82, s82, s58
s_mov_b32 s16, s14
s_and_b32 s17, s15, 0xffff
s_mov_b32 s18, 884736
s_mov_b32 s19, 0x20000
s_waitcnt vmcnt(17)
s_barrier
ds_read_b128 a[0:3], v208 offset:0
ds_read_b128 a[4:7], v208 offset:18432
ds_read_b128 a[8:11], v208 offset:36864
ds_read_b128 a[12:15], v209 offset:0
ds_read_b128 a[16:19], v209 offset:18432
ds_read_b128 a[20:23], v209 offset:36864
ds_read_b128 a[24:27], v210 offset:0
ds_read_b128 a[28:31], v210 offset:18432
ds_read_b128 a[32:35], v210 offset:36864
ds_read_b128 a[36:39], v211 offset:0
ds_read_b128 a[40:43], v211 offset:18432
ds_read_b128 a[44:47], v211 offset:36864
ds_read_b128 a[48:51], v212 offset:0
ds_read_b128 a[52:55], v212 offset:18432
ds_read_b128 a[56:59], v212 offset:36864
s_add_u32 m0, s54, 131072
s_nop 0
buffer_load_dwordx4 v40, s[28:31], s6 offen offset:0 lds
ds_read_b128 a[60:63], v213 offset:0
ds_read_b128 a[64:67], v213 offset:18432
ds_read_b128 a[68:71], v213 offset:36864
ds_read_b128 a[72:75], v214 offset:0
ds_read_b128 a[76:79], v214 offset:18432
buffer_load_dwordx4 v41, s[28:31], s6 offen offset:1024 lds
ds_read_b128 a[80:83], v214 offset:36864
ds_read_b128 a[84:87], v215 offset:0
ds_read_b128 a[88:91], v215 offset:18432
ds_read_b128 a[92:95], v215 offset:36864
ds_read_b128 a[224:227], v216 offset:0
buffer_load_dwordx4 v42, s[28:31], s6 offen offset:2048 lds
ds_read_b128 a[228:231], v216 offset:18432
ds_read_b128 a[232:235], v216 offset:36864
ds_read_b128 a[236:239], v217 offset:0
ds_read_b128 a[240:243], v217 offset:18432
ds_read_b128 a[244:247], v217 offset:36864
buffer_load_dwordx4 v43, s[28:31], s6 offen offset:3072 lds
ds_read_b128 v[112:115], v218 offset:0
ds_read_b128 v[116:119], v218 offset:18432
ds_read_b128 v[120:123], v218 offset:36864
ds_read_b128 v[124:127], v219 offset:0
ds_read_b128 v[128:131], v219 offset:18432
s_add_u32 m0, s54, 135168
s_nop 0
buffer_load_dwordx4 v44, s[28:31], s6 offen offset:0 lds
ds_read_b128 v[132:135], v219 offset:36864
ds_read_b128 v[136:139], v220 offset:0
ds_read_b128 v[140:143], v220 offset:18432
ds_read_b128 v[144:147], v220 offset:36864
ds_read_b128 v[148:151], v221 offset:0
buffer_load_dwordx4 v45, s[28:31], s6 offen offset:1024 lds
ds_read_b128 v[152:155], v221 offset:18432
ds_read_b128 v[156:159], v221 offset:36864
ds_read_b128 v[160:163], v222 offset:0
ds_read_b128 v[164:167], v222 offset:18432
ds_read_b128 v[168:171], v222 offset:36864
buffer_load_dwordx4 v46, s[28:31], s6 offen offset:2048 lds
ds_read_b128 v[172:175], v223 offset:0
ds_read_b128 v[176:179], v223 offset:18432
ds_read_b128 v[180:183], v223 offset:36864
ds_read_b128 v[184:187], v224 offset:0
ds_read_b128 v[188:191], v224 offset:18432
buffer_load_dwordx4 v47, s[28:31], s6 offen offset:3072 lds
ds_read_b128 v[192:195], v224 offset:36864
ds_read_b128 v[196:199], v225 offset:0
ds_read_b128 v[200:203], v225 offset:18432
ds_read_b128 v[204:207], v225 offset:36864
s_waitcnt vmcnt(17) lgkmcnt(0)
s_barrier
ds_read_b64_tr_b16 v[64:65], v14 offset:32768
ds_read_b64_tr_b16 v[66:67], v14 offset:33280
ds_read_b64_tr_b16 v[68:69], v15 offset:32768
ds_read_b64_tr_b16 v[70:71], v15 offset:33280
ds_read_b64_tr_b16 v[72:73], v16 offset:32768
ds_read_b64_tr_b16 v[74:75], v16 offset:33280
ds_read_b64_tr_b16 v[76:77], v17 offset:32768
ds_read_b64_tr_b16 v[78:79], v17 offset:33280
s_add_u32 m0, s54, 65536
s_nop 0
buffer_load_dwordx4 v40, s[28:31], s7 offen offset:0 lds
ds_read_b64_tr_b16 v[80:81], v14 offset:34816
ds_read_b64_tr_b16 v[82:83], v14 offset:35328
ds_read_b64_tr_b16 v[84:85], v15 offset:34816
ds_read_b64_tr_b16 v[86:87], v15 offset:35328
ds_read_b64_tr_b16 v[88:89], v16 offset:34816
ds_read_b64_tr_b16 v[90:91], v16 offset:35328
ds_read_b64_tr_b16 v[92:93], v17 offset:34816
ds_read_b64_tr_b16 v[94:95], v17 offset:35328
buffer_load_dwordx4 v41, s[28:31], s7 offen offset:1024 lds
s_waitcnt lgkmcnt(14)
v_mfma_f32_16x16x32_bf16 v[208:211], v[64:67], a[0:3], 0
v_mfma_f32_16x16x32_bf16 v[212:215], v[64:67], a[4:7], 0
buffer_load_dwordx4 v42, s[28:31], s7 offen offset:2048 lds
v_mfma_f32_16x16x32_bf16 v[216:219], v[64:67], a[8:11], 0
s_waitcnt lgkmcnt(12)
v_mfma_f32_16x16x32_bf16 v[220:223], v[68:71], a[0:3], 0
buffer_load_dwordx4 v43, s[28:31], s7 offen offset:3072 lds
v_mfma_f32_16x16x32_bf16 v[224:227], v[68:71], a[4:7], 0
s_add_u32 m0, s54, 69632
v_mfma_f32_16x16x32_bf16 v[228:231], v[68:71], a[8:11], 0
s_waitcnt lgkmcnt(10)
buffer_load_dwordx4 v44, s[28:31], s7 offen offset:0 lds
v_mfma_f32_16x16x32_bf16 v[232:235], v[72:75], a[0:3], 0
v_mfma_f32_16x16x32_bf16 v[236:239], v[72:75], a[4:7], 0
buffer_load_dwordx4 v45, s[28:31], s7 offen offset:1024 lds
v_mfma_f32_16x16x32_bf16 v[240:243], v[72:75], a[8:11], 0
s_waitcnt lgkmcnt(8)
v_mfma_f32_16x16x32_bf16 v[244:247], v[76:79], a[0:3], 0
buffer_load_dwordx4 v46, s[28:31], s7 offen offset:2048 lds
v_mfma_f32_16x16x32_bf16 v[248:251], v[76:79], a[4:7], 0
v_mfma_f32_16x16x32_bf16 v[252:255], v[76:79], a[8:11], 0
s_waitcnt lgkmcnt(6)
buffer_load_dwordx4 v47, s[28:31], s7 offen offset:3072 lds
s_waitcnt vmcnt(16)
v_mfma_f32_16x16x32_bf16 v[208:211], v[80:83], a[12:15], v[208:211]
ds_read_b64_tr_b16 v[96:97], v14 offset:0
v_mfma_f32_16x16x32_bf16 v[212:215], v[80:83], a[16:19], v[212:215]
s_add_u32 m0, s54, 98304
ds_read_b64_tr_b16 v[98:99], v14 offset:512
v_mfma_f32_16x16x32_bf16 v[216:219], v[80:83], a[20:23], v[216:219]
s_waitcnt lgkmcnt(6)
buffer_load_dwordx4 v40, s[28:31], s8 offen offset:0 lds
v_mfma_f32_16x16x32_bf16 v[220:223], v[84:87], a[12:15], v[220:223]
ds_read_b64_tr_b16 v[100:101], v15 offset:0
v_mfma_f32_16x16x32_bf16 v[224:227], v[84:87], a[16:19], v[224:227]
ds_read_b64_tr_b16 v[102:103], v15 offset:512
v_mfma_f32_16x16x32_bf16 v[228:231], v[84:87], a[20:23], v[228:231]
s_waitcnt lgkmcnt(6)
v_mfma_f32_16x16x32_bf16 v[232:235], v[88:91], a[12:15], v[232:235]
ds_read_b64_tr_b16 v[104:105], v16 offset:0
v_mfma_f32_16x16x32_bf16 v[236:239], v[88:91], a[16:19], v[236:239]
ds_read_b64_tr_b16 v[106:107], v16 offset:512
v_mfma_f32_16x16x32_bf16 v[240:243], v[88:91], a[20:23], v[240:243]
s_waitcnt lgkmcnt(6)
buffer_load_dwordx4 v41, s[28:31], s8 offen offset:1024 lds
v_mfma_f32_16x16x32_bf16 v[244:247], v[92:95], a[12:15], v[244:247]
ds_read_b64_tr_b16 v[108:109], v17 offset:0
v_mfma_f32_16x16x32_bf16 v[248:251], v[92:95], a[16:19], v[248:251]
ds_read_b64_tr_b16 v[110:111], v17 offset:512
v_mfma_f32_16x16x32_bf16 v[252:255], v[92:95], a[20:23], v[252:255]
s_waitcnt lgkmcnt(6)
buffer_load_dwordx4 v42, s[28:31], s8 offen offset:2048 lds
v_mfma_f32_16x16x32_bf16 v[208:211], v[96:99], a[24:27], v[208:211]
ds_read_b64_tr_b16 v[64:65], v14 offset:2048
v_mfma_f32_16x16x32_bf16 v[212:215], v[96:99], a[28:31], v[212:215]
ds_read_b64_tr_b16 v[66:67], v14 offset:2560
v_add_u32 v14, 131072, v14
v_mfma_f32_16x16x32_bf16 v[216:219], v[96:99], a[32:35], v[216:219]
s_waitcnt lgkmcnt(6)
buffer_load_dwordx4 v43, s[28:31], s8 offen offset:3072 lds
v_mfma_f32_16x16x32_bf16 v[220:223], v[100:103], a[24:27], v[220:223]
ds_read_b64_tr_b16 v[68:69], v15 offset:2048
v_mfma_f32_16x16x32_bf16 v[224:227], v[100:103], a[28:31], v[224:227]
s_add_u32 m0, s54, 102400
ds_read_b64_tr_b16 v[70:71], v15 offset:2560
v_mfma_f32_16x16x32_bf16 v[228:231], v[100:103], a[32:35], v[228:231]
s_waitcnt lgkmcnt(6)
buffer_load_dwordx4 v44, s[28:31], s8 offen offset:0 lds
v_mfma_f32_16x16x32_bf16 v[232:235], v[104:107], a[24:27], v[232:235]
ds_read_b64_tr_b16 v[72:73], v16 offset:2048
v_add_u32 v15, 131072, v15
v_mfma_f32_16x16x32_bf16 v[236:239], v[104:107], a[28:31], v[236:239]
ds_read_b64_tr_b16 v[74:75], v16 offset:2560
v_add_u32 v16, 131072, v16
v_mfma_f32_16x16x32_bf16 v[240:243], v[104:107], a[32:35], v[240:243]
s_waitcnt lgkmcnt(6)
buffer_load_dwordx4 v45, s[28:31], s8 offen offset:1024 lds
v_mfma_f32_16x16x32_bf16 v[244:247], v[108:111], a[24:27], v[244:247]
ds_read_b64_tr_b16 v[76:77], v17 offset:2048
v_mfma_f32_16x16x32_bf16 v[248:251], v[108:111], a[28:31], v[248:251]
ds_read_b64_tr_b16 v[78:79], v17 offset:2560
v_add_u32 v17, 131072, v17
v_mfma_f32_16x16x32_bf16 v[252:255], v[108:111], a[32:35], v[252:255]
s_waitcnt lgkmcnt(6)
buffer_load_dwordx4 v46, s[28:31], s8 offen offset:2048 lds
s_waitcnt vmcnt(15)
v_mfma_f32_16x16x32_bf16 v[208:211], v[64:67], a[36:39], v[208:211]
ds_read_b64_tr_b16 v[80:81], v14 offset:0
v_mfma_f32_16x16x32_bf16 v[212:215], v[64:67], a[40:43], v[212:215]
ds_read_b64_tr_b16 v[82:83], v14 offset:512
v_mfma_f32_16x16x32_bf16 v[216:219], v[64:67], a[44:47], v[216:219]
s_waitcnt lgkmcnt(6)
buffer_load_dwordx4 v47, s[28:31], s8 offen offset:3072 lds
v_mfma_f32_16x16x32_bf16 v[220:223], v[68:71], a[36:39], v[220:223]
ds_read_b64_tr_b16 v[84:85], v15 offset:0
v_mfma_f32_16x16x32_bf16 v[224:227], v[68:71], a[40:43], v[224:227]
s_add_u32 m0, s54, 32768
ds_read_b64_tr_b16 v[86:87], v15 offset:512
v_mfma_f32_16x16x32_bf16 v[228:231], v[68:71], a[44:47], v[228:231]
s_waitcnt lgkmcnt(6)
buffer_load_dwordx4 v40, s[28:31], s9 offen offset:0 lds
v_mfma_f32_16x16x32_bf16 v[232:235], v[72:75], a[36:39], v[232:235]
ds_read_b64_tr_b16 v[88:89], v16 offset:0
v_mfma_f32_16x16x32_bf16 v[236:239], v[72:75], a[40:43], v[236:239]
ds_read_b64_tr_b16 v[90:91], v16 offset:512
v_mfma_f32_16x16x32_bf16 v[240:243], v[72:75], a[44:47], v[240:243]
s_waitcnt lgkmcnt(6)
buffer_load_dwordx4 v41, s[28:31], s9 offen offset:1024 lds
v_mfma_f32_16x16x32_bf16 v[244:247], v[76:79], a[36:39], v[244:247]
ds_read_b64_tr_b16 v[92:93], v17 offset:0
v_mfma_f32_16x16x32_bf16 v[248:251], v[76:79], a[40:43], v[248:251]
ds_read_b64_tr_b16 v[94:95], v17 offset:512
v_mfma_f32_16x16x32_bf16 v[252:255], v[76:79], a[44:47], v[252:255]
s_waitcnt lgkmcnt(6)
buffer_load_dwordx4 v42, s[28:31], s9 offen offset:2048 lds
v_mfma_f32_16x16x32_bf16 v[208:211], v[80:83], a[48:51], v[208:211]
ds_read_b64_tr_b16 v[96:97], v14 offset:2048
v_mfma_f32_16x16x32_bf16 v[212:215], v[80:83], a[52:55], v[212:215]
ds_read_b64_tr_b16 v[98:99], v14 offset:2560
v_add_u32 v14, 4294901760, v14
v_mfma_f32_16x16x32_bf16 v[216:219], v[80:83], a[56:59], v[216:219]
s_waitcnt lgkmcnt(6)
v_mfma_f32_16x16x32_bf16 v[220:223], v[84:87], a[48:51], v[220:223]
ds_read_b64_tr_b16 v[100:101], v15 offset:2048
v_mfma_f32_16x16x32_bf16 v[224:227], v[84:87], a[52:55], v[224:227]
ds_read_b64_tr_b16 v[102:103], v15 offset:2560
v_add_u32 v15, 4294901760, v15
v_mfma_f32_16x16x32_bf16 v[228:231], v[84:87], a[56:59], v[228:231]
s_waitcnt lgkmcnt(6)
buffer_load_dwordx4 v43, s[28:31], s9 offen offset:3072 lds
v_mfma_f32_16x16x32_bf16 v[232:235], v[88:91], a[48:51], v[232:235]
ds_read_b64_tr_b16 v[104:105], v16 offset:2048
v_mfma_f32_16x16x32_bf16 v[236:239], v[88:91], a[52:55], v[236:239]
s_add_u32 m0, s54, 36864
ds_read_b64_tr_b16 v[106:107], v16 offset:2560
v_mfma_f32_16x16x32_bf16 v[240:243], v[88:91], a[56:59], v[240:243]
s_waitcnt lgkmcnt(6)
buffer_load_dwordx4 v44, s[28:31], s9 offen offset:0 lds
v_mfma_f32_16x16x32_bf16 v[244:247], v[92:95], a[48:51], v[244:247]
ds_read_b64_tr_b16 v[108:109], v17 offset:2048
v_add_u32 v16, 4294901760, v16
v_mfma_f32_16x16x32_bf16 v[248:251], v[92:95], a[52:55], v[248:251]
ds_read_b64_tr_b16 v[110:111], v17 offset:2560
v_add_u32 v17, 4294901760, v17
v_mfma_f32_16x16x32_bf16 v[252:255], v[92:95], a[56:59], v[252:255]
s_waitcnt lgkmcnt(6)
buffer_load_dwordx4 v45, s[28:31], s9 offen offset:1024 lds
s_waitcnt vmcnt(14)
v_mfma_f32_16x16x32_bf16 v[208:211], v[96:99], a[60:63], v[208:211]
ds_read_b64_tr_b16 v[64:65], v14 offset:0
v_mfma_f32_16x16x32_bf16 v[212:215], v[96:99], a[64:67], v[212:215]
ds_read_b64_tr_b16 v[66:67], v14 offset:512
v_mfma_f32_16x16x32_bf16 v[216:219], v[96:99], a[68:71], v[216:219]
s_waitcnt lgkmcnt(6)
buffer_load_dwordx4 v46, s[28:31], s9 offen offset:2048 lds
v_mfma_f32_16x16x32_bf16 v[220:223], v[100:103], a[60:63], v[220:223]
ds_read_b64_tr_b16 v[68:69], v15 offset:0
v_mfma_f32_16x16x32_bf16 v[224:227], v[100:103], a[64:67], v[224:227]
ds_read_b64_tr_b16 v[70:71], v15 offset:512
v_mfma_f32_16x16x32_bf16 v[228:231], v[100:103], a[68:71], v[228:231]
s_waitcnt lgkmcnt(6)
buffer_load_dwordx4 v47, s[28:31], s9 offen offset:3072 lds
v_mfma_f32_16x16x32_bf16 v[232:235], v[104:107], a[60:63], v[232:235]
ds_read_b64_tr_b16 v[72:73], v16 offset:0
v_mfma_f32_16x16x32_bf16 v[236:239], v[104:107], a[64:67], v[236:239]
s_add_u32 m0, s54, 0
ds_read_b64_tr_b16 v[74:75], v16 offset:512
v_mfma_f32_16x16x32_bf16 v[240:243], v[104:107], a[68:71], v[240:243]
s_waitcnt lgkmcnt(6)
buffer_load_dwordx4 v40, s[28:31], s10 offen offset:0 lds
v_mfma_f32_16x16x32_bf16 v[244:247], v[108:111], a[60:63], v[244:247]
ds_read_b64_tr_b16 v[76:77], v17 offset:0
v_mfma_f32_16x16x32_bf16 v[248:251], v[108:111], a[64:67], v[248:251]
ds_read_b64_tr_b16 v[78:79], v17 offset:512
v_mfma_f32_16x16x32_bf16 v[252:255], v[108:111], a[68:71], v[252:255]
s_waitcnt lgkmcnt(6)
buffer_load_dwordx4 v41, s[28:31], s10 offen offset:1024 lds
v_mfma_f32_16x16x32_bf16 v[208:211], v[64:67], a[72:75], v[208:211]
ds_read_b64_tr_b16 v[80:81], v14 offset:2048
v_mfma_f32_16x16x32_bf16 v[212:215], v[64:67], a[76:79], v[212:215]
ds_read_b64_tr_b16 v[82:83], v14 offset:2560
v_mfma_f32_16x16x32_bf16 v[216:219], v[64:67], a[80:83], v[216:219]
s_waitcnt lgkmcnt(6)
buffer_load_dwordx4 v42, s[28:31], s10 offen offset:2048 lds
v_mfma_f32_16x16x32_bf16 v[220:223], v[68:71], a[72:75], v[220:223]
ds_read_b64_tr_b16 v[84:85], v15 offset:2048
v_mfma_f32_16x16x32_bf16 v[224:227], v[68:71], a[76:79], v[224:227]
ds_read_b64_tr_b16 v[86:87], v15 offset:2560
v_mfma_f32_16x16x32_bf16 v[228:231], v[68:71], a[80:83], v[228:231]
s_waitcnt lgkmcnt(6)
buffer_load_dwordx4 v43, s[28:31], s10 offen offset:3072 lds
v_mfma_f32_16x16x32_bf16 v[232:235], v[72:75], a[72:75], v[232:235]
ds_read_b64_tr_b16 v[88:89], v16 offset:2048
v_mfma_f32_16x16x32_bf16 v[236:239], v[72:75], a[76:79], v[236:239]
s_add_u32 m0, s54, 4096
ds_read_b64_tr_b16 v[90:91], v16 offset:2560
v_mfma_f32_16x16x32_bf16 v[240:243], v[72:75], a[80:83], v[240:243]
s_waitcnt lgkmcnt(6)
buffer_load_dwordx4 v44, s[28:31], s10 offen offset:0 lds
v_mfma_f32_16x16x32_bf16 v[244:247], v[76:79], a[72:75], v[244:247]
ds_read_b64_tr_b16 v[92:93], v17 offset:2048
v_mfma_f32_16x16x32_bf16 v[248:251], v[76:79], a[76:79], v[248:251]
ds_read_b64_tr_b16 v[94:95], v17 offset:2560
v_mfma_f32_16x16x32_bf16 v[252:255], v[76:79], a[80:83], v[252:255]
s_waitcnt lgkmcnt(6)
s_waitcnt vmcnt(13)
v_mfma_f32_16x16x32_bf16 v[208:211], v[80:83], a[84:87], v[208:211]
ds_read_b64_tr_b16 v[96:97], v14 offset:32768
v_mfma_f32_16x16x32_bf16 v[212:215], v[80:83], a[88:91], v[212:215]
ds_read_b64_tr_b16 v[98:99], v14 offset:33280
v_mfma_f32_16x16x32_bf16 v[216:219], v[80:83], a[92:95], v[216:219]
s_waitcnt lgkmcnt(6)
buffer_load_dwordx4 v45, s[28:31], s10 offen offset:1024 lds
v_mfma_f32_16x16x32_bf16 v[220:223], v[84:87], a[84:87], v[220:223]
ds_read_b64_tr_b16 v[100:101], v15 offset:32768
v_mfma_f32_16x16x32_bf16 v[224:227], v[84:87], a[88:91], v[224:227]
ds_read_b64_tr_b16 v[102:103], v15 offset:33280
v_mfma_f32_16x16x32_bf16 v[228:231], v[84:87], a[92:95], v[228:231]
s_waitcnt lgkmcnt(6)
buffer_load_dwordx4 v46, s[28:31], s10 offen offset:2048 lds
v_mfma_f32_16x16x32_bf16 v[232:235], v[88:91], a[84:87], v[232:235]
ds_read_b64_tr_b16 v[104:105], v16 offset:32768
v_mfma_f32_16x16x32_bf16 v[236:239], v[88:91], a[88:91], v[236:239]
ds_read_b64_tr_b16 v[106:107], v16 offset:33280
v_mfma_f32_16x16x32_bf16 v[240:243], v[88:91], a[92:95], v[240:243]
s_waitcnt lgkmcnt(6)
buffer_load_dwordx4 v47, s[28:31], s10 offen offset:3072 lds
v_mfma_f32_16x16x32_bf16 v[244:247], v[92:95], a[84:87], v[244:247]
ds_read_b64_tr_b16 v[108:109], v17 offset:32768
v_mfma_f32_16x16x32_bf16 v[248:251], v[92:95], a[88:91], v[248:251]
s_add_u32 m0, s54, 131072
ds_read_b64_tr_b16 v[110:111], v17 offset:33280
v_mfma_f32_16x16x32_bf16 v[252:255], v[92:95], a[92:95], v[252:255]
s_waitcnt lgkmcnt(6)
buffer_load_dwordx4 v40, s[28:31], s11 offen offset:0 lds
v_mfma_f32_16x16x32_bf16 v[208:211], v[96:99], a[224:227], v[208:211]
ds_read_b64_tr_b16 v[64:65], v14 offset:34816
v_mfma_f32_16x16x32_bf16 v[212:215], v[96:99], a[228:231], v[212:215]
ds_read_b64_tr_b16 v[66:67], v14 offset:35328
v_add_u32 v14, 4294901760, v14
v_mfma_f32_16x16x32_bf16 v[216:219], v[96:99], a[232:235], v[216:219]
s_waitcnt lgkmcnt(6)
buffer_load_dwordx4 v41, s[28:31], s11 offen offset:1024 lds
v_mfma_f32_16x16x32_bf16 v[220:223], v[100:103], a[224:227], v[220:223]
ds_read_b64_tr_b16 v[68:69], v15 offset:34816
v_mfma_f32_16x16x32_bf16 v[224:227], v[100:103], a[228:231], v[224:227]
ds_read_b64_tr_b16 v[70:71], v15 offset:35328
v_add_u32 v15, 4294901760, v15
v_mfma_f32_16x16x32_bf16 v[228:231], v[100:103], a[232:235], v[228:231]
s_waitcnt lgkmcnt(6)
buffer_load_dwordx4 v42, s[28:31], s11 offen offset:2048 lds
v_mfma_f32_16x16x32_bf16 v[232:235], v[104:107], a[224:227], v[232:235]
ds_read_b64_tr_b16 v[72:73], v16 offset:34816
v_mfma_f32_16x16x32_bf16 v[236:239], v[104:107], a[228:231], v[236:239]
ds_read_b64_tr_b16 v[74:75], v16 offset:35328
v_add_u32 v16, 4294901760, v16
v_mfma_f32_16x16x32_bf16 v[240:243], v[104:107], a[232:235], v[240:243]
s_waitcnt lgkmcnt(6)
buffer_load_dwordx4 v43, s[28:31], s11 offen offset:3072 lds
v_mfma_f32_16x16x32_bf16 v[244:247], v[108:111], a[224:227], v[244:247]
ds_read_b64_tr_b16 v[76:77], v17 offset:34816
v_mfma_f32_16x16x32_bf16 v[248:251], v[108:111], a[228:231], v[248:251]
s_add_u32 m0, s54, 135168
ds_read_b64_tr_b16 v[78:79], v17 offset:35328
v_mfma_f32_16x16x32_bf16 v[252:255], v[108:111], a[232:235], v[252:255]
s_waitcnt lgkmcnt(6)
buffer_load_dwordx4 v44, s[28:31], s11 offen offset:0 lds
v_add_u32 v17, 4294901760, v17
s_waitcnt vmcnt(13)
v_mfma_f32_16x16x32_bf16 v[208:211], v[64:67], a[236:239], v[208:211]
ds_read_b64_tr_b16 v[80:81], v14 offset:32768
v_mfma_f32_16x16x32_bf16 v[212:215], v[64:67], a[240:243], v[212:215]
ds_read_b64_tr_b16 v[82:83], v14 offset:33280
v_mfma_f32_16x16x32_bf16 v[216:219], v[64:67], a[244:247], v[216:219]
s_waitcnt lgkmcnt(6)
buffer_load_dwordx4 v45, s[28:31], s11 offen offset:1024 lds
v_mfma_f32_16x16x32_bf16 v[220:223], v[68:71], a[236:239], v[220:223]
ds_read_b64_tr_b16 v[84:85], v15 offset:32768
v_mfma_f32_16x16x32_bf16 v[224:227], v[68:71], a[240:243], v[224:227]
ds_read_b64_tr_b16 v[86:87], v15 offset:33280
v_mfma_f32_16x16x32_bf16 v[228:231], v[68:71], a[244:247], v[228:231]
s_waitcnt lgkmcnt(6)
buffer_load_dwordx4 v46, s[28:31], s11 offen offset:2048 lds
v_mfma_f32_16x16x32_bf16 v[232:235], v[72:75], a[236:239], v[232:235]
ds_read_b64_tr_b16 v[88:89], v16 offset:32768
v_mfma_f32_16x16x32_bf16 v[236:239], v[72:75], a[240:243], v[236:239]
ds_read_b64_tr_b16 v[90:91], v16 offset:33280
v_mfma_f32_16x16x32_bf16 v[240:243], v[72:75], a[244:247], v[240:243]
s_waitcnt lgkmcnt(6)
v_mfma_f32_16x16x32_bf16 v[244:247], v[76:79], a[236:239], v[244:247]
ds_read_b64_tr_b16 v[92:93], v17 offset:32768
v_mfma_f32_16x16x32_bf16 v[248:251], v[76:79], a[240:243], v[248:251]
ds_read_b64_tr_b16 v[94:95], v17 offset:33280
v_mfma_f32_16x16x32_bf16 v[252:255], v[76:79], a[244:247], v[252:255]
s_waitcnt lgkmcnt(6)
buffer_load_dwordx4 v47, s[28:31], s11 offen offset:3072 lds
v_mfma_f32_16x16x32_bf16 v[208:211], v[80:83], v[112:115], v[208:211]
ds_read_b64_tr_b16 v[96:97], v14 offset:34816
v_mfma_f32_16x16x32_bf16 v[212:215], v[80:83], v[116:119], v[212:215]
s_add_u32 m0, s54, 65536
ds_read_b64_tr_b16 v[98:99], v14 offset:35328
v_mfma_f32_16x16x32_bf16 v[216:219], v[80:83], v[120:123], v[216:219]
s_waitcnt lgkmcnt(6)
buffer_load_dwordx4 v40, s[28:31], s12 offen offset:0 lds
v_mfma_f32_16x16x32_bf16 v[220:223], v[84:87], v[112:115], v[220:223]
ds_read_b64_tr_b16 v[100:101], v15 offset:34816
v_mfma_f32_16x16x32_bf16 v[224:227], v[84:87], v[116:119], v[224:227]
ds_read_b64_tr_b16 v[102:103], v15 offset:35328
v_mfma_f32_16x16x32_bf16 v[228:231], v[84:87], v[120:123], v[228:231]
s_waitcnt lgkmcnt(6)
buffer_load_dwordx4 v41, s[28:31], s12 offen offset:1024 lds
v_mfma_f32_16x16x32_bf16 v[232:235], v[88:91], v[112:115], v[232:235]
ds_read_b64_tr_b16 v[104:105], v16 offset:34816
v_mfma_f32_16x16x32_bf16 v[236:239], v[88:91], v[116:119], v[236:239]
ds_read_b64_tr_b16 v[106:107], v16 offset:35328
v_mfma_f32_16x16x32_bf16 v[240:243], v[88:91], v[120:123], v[240:243]
s_waitcnt lgkmcnt(6)
buffer_load_dwordx4 v42, s[28:31], s12 offen offset:2048 lds
v_mfma_f32_16x16x32_bf16 v[244:247], v[92:95], v[112:115], v[244:247]
ds_read_b64_tr_b16 v[108:109], v17 offset:34816
v_mfma_f32_16x16x32_bf16 v[248:251], v[92:95], v[116:119], v[248:251]
ds_read_b64_tr_b16 v[110:111], v17 offset:35328
v_mfma_f32_16x16x32_bf16 v[252:255], v[92:95], v[120:123], v[252:255]
s_waitcnt lgkmcnt(6)
buffer_load_dwordx4 v43, s[28:31], s12 offen offset:3072 lds
s_waitcnt vmcnt(12)
v_mfma_f32_16x16x32_bf16 v[208:211], v[96:99], v[124:127], v[208:211]
ds_read_b64_tr_b16 v[64:65], v14 offset:0
v_mfma_f32_16x16x32_bf16 v[212:215], v[96:99], v[128:131], v[212:215]
s_add_u32 m0, s54, 69632
ds_read_b64_tr_b16 v[66:67], v14 offset:512
v_mfma_f32_16x16x32_bf16 v[216:219], v[96:99], v[132:135], v[216:219]
s_waitcnt lgkmcnt(6)
buffer_load_dwordx4 v44, s[28:31], s12 offen offset:0 lds
v_mfma_f32_16x16x32_bf16 v[220:223], v[100:103], v[124:127], v[220:223]
ds_read_b64_tr_b16 v[68:69], v15 offset:0
v_mfma_f32_16x16x32_bf16 v[224:227], v[100:103], v[128:131], v[224:227]
ds_read_b64_tr_b16 v[70:71], v15 offset:512
v_mfma_f32_16x16x32_bf16 v[228:231], v[100:103], v[132:135], v[228:231]
s_waitcnt lgkmcnt(6)
buffer_load_dwordx4 v45, s[28:31], s12 offen offset:1024 lds
v_mfma_f32_16x16x32_bf16 v[232:235], v[104:107], v[124:127], v[232:235]
ds_read_b64_tr_b16 v[72:73], v16 offset:0
v_mfma_f32_16x16x32_bf16 v[236:239], v[104:107], v[128:131], v[236:239]
ds_read_b64_tr_b16 v[74:75], v16 offset:512
v_mfma_f32_16x16x32_bf16 v[240:243], v[104:107], v[132:135], v[240:243]
s_waitcnt lgkmcnt(6)
buffer_load_dwordx4 v46, s[28:31], s12 offen offset:2048 lds
v_mfma_f32_16x16x32_bf16 v[244:247], v[108:111], v[124:127], v[244:247]
ds_read_b64_tr_b16 v[76:77], v17 offset:0
v_mfma_f32_16x16x32_bf16 v[248:251], v[108:111], v[128:131], v[248:251]
ds_read_b64_tr_b16 v[78:79], v17 offset:512
v_mfma_f32_16x16x32_bf16 v[252:255], v[108:111], v[132:135], v[252:255]
s_waitcnt lgkmcnt(6)
buffer_load_dwordx4 v47, s[28:31], s12 offen offset:3072 lds
v_mfma_f32_16x16x32_bf16 v[208:211], v[64:67], v[136:139], v[208:211]
ds_read_b64_tr_b16 v[80:81], v14 offset:2048
v_mfma_f32_16x16x32_bf16 v[212:215], v[64:67], v[140:143], v[212:215]
s_add_u32 m0, s54, 98304
ds_read_b64_tr_b16 v[82:83], v14 offset:2560
v_mfma_f32_16x16x32_bf16 v[216:219], v[64:67], v[144:147], v[216:219]
s_waitcnt lgkmcnt(6)
buffer_load_dwordx4 v9, s[20:23], s43 offen offset:0 lds
v_mfma_f32_16x16x32_bf16 v[220:223], v[68:71], v[136:139], v[220:223]
ds_read_b64_tr_b16 v[84:85], v15 offset:2048
v_add_u32 v14, 131072, v14
v_mfma_f32_16x16x32_bf16 v[224:227], v[68:71], v[140:143], v[224:227]
ds_read_b64_tr_b16 v[86:87], v15 offset:2560
v_add_u32 v15, 131072, v15
v_mfma_f32_16x16x32_bf16 v[228:231], v[68:71], v[144:147], v[228:231]
s_waitcnt lgkmcnt(6)
v_mfma_f32_16x16x32_bf16 v[232:235], v[72:75], v[136:139], v[232:235]
ds_read_b64_tr_b16 v[88:89], v16 offset:2048
v_mfma_f32_16x16x32_bf16 v[236:239], v[72:75], v[140:143], v[236:239]
ds_read_b64_tr_b16 v[90:91], v16 offset:2560
v_add_u32 v16, 131072, v16
v_mfma_f32_16x16x32_bf16 v[240:243], v[72:75], v[144:147], v[240:243]
s_waitcnt lgkmcnt(6)
buffer_load_dwordx4 v10, s[20:23], s43 offen offset:1024 lds
v_mfma_f32_16x16x32_bf16 v[244:247], v[76:79], v[136:139], v[244:247]
ds_read_b64_tr_b16 v[92:93], v17 offset:2048
v_mfma_f32_16x16x32_bf16 v[248:251], v[76:79], v[140:143], v[248:251]
ds_read_b64_tr_b16 v[94:95], v17 offset:2560
v_add_u32 v17, 131072, v17
v_mfma_f32_16x16x32_bf16 v[252:255], v[76:79], v[144:147], v[252:255]
s_waitcnt lgkmcnt(6)
buffer_load_dwordx4 v11, s[20:23], s43 offen offset:2048 lds
s_waitcnt vmcnt(11)
v_mfma_f32_16x16x32_bf16 v[208:211], v[80:83], v[148:151], v[208:211]
ds_read_b64_tr_b16 v[96:97], v14 offset:0
v_mfma_f32_16x16x32_bf16 v[212:215], v[80:83], v[152:155], v[212:215]
ds_read_b64_tr_b16 v[98:99], v14 offset:512
v_mfma_f32_16x16x32_bf16 v[216:219], v[80:83], v[156:159], v[216:219]
s_waitcnt lgkmcnt(6)
v_mfma_f32_16x16x32_bf16 v[220:223], v[84:87], v[148:151], v[220:223]
ds_read_b64_tr_b16 v[100:101], v15 offset:0
v_mfma_f32_16x16x32_bf16 v[224:227], v[84:87], v[152:155], v[224:227]
ds_read_b64_tr_b16 v[102:103], v15 offset:512
v_mfma_f32_16x16x32_bf16 v[228:231], v[84:87], v[156:159], v[228:231]
s_waitcnt lgkmcnt(6)
buffer_load_dwordx4 v12, s[20:23], s43 offen offset:3072 lds
v_mfma_f32_16x16x32_bf16 v[232:235], v[88:91], v[148:151], v[232:235]
ds_read_b64_tr_b16 v[104:105], v16 offset:0
v_mfma_f32_16x16x32_bf16 v[236:239], v[88:91], v[152:155], v[236:239]
s_add_u32 m0, s54, 102400
ds_read_b64_tr_b16 v[106:107], v16 offset:512
v_mfma_f32_16x16x32_bf16 v[240:243], v[88:91], v[156:159], v[240:243]
s_waitcnt lgkmcnt(6)
buffer_load_dwordx4 v9, s[20:23], s44 offen offset:0 lds
v_mfma_f32_16x16x32_bf16 v[244:247], v[92:95], v[148:151], v[244:247]
ds_read_b64_tr_b16 v[108:109], v17 offset:0
v_mfma_f32_16x16x32_bf16 v[248:251], v[92:95], v[152:155], v[248:251]
ds_read_b64_tr_b16 v[110:111], v17 offset:512
v_mfma_f32_16x16x32_bf16 v[252:255], v[92:95], v[156:159], v[252:255]
s_waitcnt lgkmcnt(6)
v_mfma_f32_16x16x32_bf16 v[208:211], v[96:99], v[160:163], v[208:211]
ds_read_b64_tr_b16 v[64:65], v14 offset:2048
v_mfma_f32_16x16x32_bf16 v[212:215], v[96:99], v[164:167], v[212:215]
ds_read_b64_tr_b16 v[66:67], v14 offset:2560
v_add_u32 v14, 4294901760, v14
v_mfma_f32_16x16x32_bf16 v[216:219], v[96:99], v[168:171], v[216:219]
s_waitcnt lgkmcnt(6)
buffer_load_dwordx4 v10, s[20:23], s44 offen offset:1024 lds
v_mfma_f32_16x16x32_bf16 v[220:223], v[100:103], v[160:163], v[220:223]
ds_read_b64_tr_b16 v[68:69], v15 offset:2048
v_mfma_f32_16x16x32_bf16 v[224:227], v[100:103], v[164:167], v[224:227]
ds_read_b64_tr_b16 v[70:71], v15 offset:2560
v_add_u32 v15, 4294901760, v15
v_mfma_f32_16x16x32_bf16 v[228:231], v[100:103], v[168:171], v[228:231]
s_waitcnt lgkmcnt(6)
buffer_load_dwordx4 v11, s[20:23], s44 offen offset:2048 lds
v_mfma_f32_16x16x32_bf16 v[232:235], v[104:107], v[160:163], v[232:235]
ds_read_b64_tr_b16 v[72:73], v16 offset:2048
v_mfma_f32_16x16x32_bf16 v[236:239], v[104:107], v[164:167], v[236:239]
ds_read_b64_tr_b16 v[74:75], v16 offset:2560
v_add_u32 v16, 4294901760, v16
v_mfma_f32_16x16x32_bf16 v[240:243], v[104:107], v[168:171], v[240:243]
s_waitcnt lgkmcnt(6)
v_mfma_f32_16x16x32_bf16 v[244:247], v[108:111], v[160:163], v[244:247]
ds_read_b64_tr_b16 v[76:77], v17 offset:2048
v_mfma_f32_16x16x32_bf16 v[248:251], v[108:111], v[164:167], v[248:251]
ds_read_b64_tr_b16 v[78:79], v17 offset:2560
v_add_u32 v17, 4294901760, v17
v_mfma_f32_16x16x32_bf16 v[252:255], v[108:111], v[168:171], v[252:255]
s_waitcnt lgkmcnt(6)
buffer_load_dwordx4 v12, s[20:23], s44 offen offset:3072 lds
v_mfma_f32_16x16x32_bf16 v[208:211], v[64:67], v[172:175], v[208:211]
v_mfma_f32_16x16x32_bf16 v[212:215], v[64:67], v[176:179], v[212:215]
s_add_u32 m0, s54, 32768
v_mfma_f32_16x16x32_bf16 v[216:219], v[64:67], v[180:183], v[216:219]
s_waitcnt lgkmcnt(4)
buffer_load_dwordx4 v9, s[20:23], s45 offen offset:0 lds
v_mfma_f32_16x16x32_bf16 v[220:223], v[68:71], v[172:175], v[220:223]
v_mfma_f32_16x16x32_bf16 v[224:227], v[68:71], v[176:179], v[224:227]
v_mfma_f32_16x16x32_bf16 v[228:231], v[68:71], v[180:183], v[228:231]
s_waitcnt lgkmcnt(2)
s_waitcnt vmcnt(9)
v_mfma_f32_16x16x32_bf16 v[232:235], v[72:75], v[172:175], v[232:235]
ds_read_b64_tr_b16 v[80:81], v14 offset:0
ds_read_b64_tr_b16 v[82:83], v14 offset:512
v_mfma_f32_16x16x32_bf16 v[236:239], v[72:75], v[176:179], v[236:239]
ds_read_b64_tr_b16 v[96:97], v14 offset:2048
ds_read_b64_tr_b16 v[98:99], v14 offset:2560
v_mfma_f32_16x16x32_bf16 v[240:243], v[72:75], v[180:183], v[240:243]
s_waitcnt lgkmcnt(4)
ds_read_b64_tr_b16 v[84:85], v15 offset:0
ds_read_b64_tr_b16 v[86:87], v15 offset:512
v_mfma_f32_16x16x32_bf16 v[244:247], v[76:79], v[172:175], v[244:247]
ds_read_b64_tr_b16 v[100:101], v15 offset:2048
ds_read_b64_tr_b16 v[102:103], v15 offset:2560
v_mfma_f32_16x16x32_bf16 v[248:251], v[76:79], v[176:179], v[248:251]
ds_read_b64_tr_b16 v[88:89], v16 offset:0
v_mfma_f32_16x16x32_bf16 v[252:255], v[76:79], v[180:183], v[252:255]
s_waitcnt lgkmcnt(7)
ds_read_b64_tr_b16 v[90:91], v16 offset:512
v_mfma_f32_16x16x32_bf16 v[208:211], v[80:83], v[184:187], v[208:211]
ds_read_b64_tr_b16 v[104:105], v16 offset:2048
v_mfma_f32_16x16x32_bf16 v[212:215], v[80:83], v[188:191], v[212:215]
ds_read_b64_tr_b16 v[106:107], v16 offset:2560
v_mfma_f32_16x16x32_bf16 v[216:219], v[80:83], v[192:195], v[216:219]
s_waitcnt lgkmcnt(8)
ds_read_b64_tr_b16 v[92:93], v17 offset:0
v_mfma_f32_16x16x32_bf16 v[208:211], v[96:99], v[196:199], v[208:211]
ds_read_b64_tr_b16 v[94:95], v17 offset:512
v_mfma_f32_16x16x32_bf16 v[212:215], v[96:99], v[200:203], v[212:215]
ds_read_b64_tr_b16 v[108:109], v17 offset:2048
v_mfma_f32_16x16x32_bf16 v[216:219], v[96:99], v[204:207], v[216:219]
s_waitcnt lgkmcnt(9)
ds_read_b64_tr_b16 v[110:111], v17 offset:2560
v_mfma_f32_16x16x32_bf16 v[220:223], v[84:87], v[184:187], v[220:223]
buffer_load_dwordx4 v10, s[20:23], s45 offen offset:1024 lds
v_mfma_f32_16x16x32_bf16 v[224:227], v[84:87], v[188:191], v[224:227]
v_mul_f32 v208, v56, v208
v_mul_f32 v209, v56, v209
v_mfma_f32_16x16x32_bf16 v[228:231], v[84:87], v[192:195], v[228:231]
s_waitcnt lgkmcnt(8)
buffer_load_dwordx4 v11, s[20:23], s45 offen offset:2048 lds
v_mfma_f32_16x16x32_bf16 v[220:223], v[100:103], v[196:199], v[220:223]
v_mul_f32 v210, v56, v210
v_mul_f32 v211, v56, v211
v_mfma_f32_16x16x32_bf16 v[224:227], v[100:103], v[200:203], v[224:227]
buffer_load_dwordx4 v12, s[20:23], s45 offen offset:3072 lds
v_mfma_f32_16x16x32_bf16 v[228:231], v[100:103], v[204:207], v[228:231]
s_waitcnt lgkmcnt(6)
s_add_u32 m0, s54, 36864
v_cvt_pk_bf16_f32 v208, v208, v209
v_mfma_f32_16x16x32_bf16 v[232:235], v[88:91], v[184:187], v[232:235]
buffer_load_dwordx4 v9, s[20:23], s46 offen offset:0 lds
v_mfma_f32_16x16x32_bf16 v[236:239], v[88:91], v[188:191], v[236:239]
v_cvt_pk_bf16_f32 v209, v210, v211
v_mul_f32 v212, v56, v212
v_mfma_f32_16x16x32_bf16 v[240:243], v[88:91], v[192:195], v[240:243]
s_waitcnt lgkmcnt(4)
buffer_load_dwordx4 v10, s[20:23], s46 offen offset:1024 lds
v_mfma_f32_16x16x32_bf16 v[232:235], v[104:107], v[196:199], v[232:235]
ds_write_b64 v35, v[208:209] offset:0
v_mfma_f32_16x16x32_bf16 v[236:239], v[104:107], v[200:203], v[236:239]
buffer_load_dwordx4 v11, s[20:23], s46 offen offset:2048 lds
v_mfma_f32_16x16x32_bf16 v[240:243], v[104:107], v[204:207], v[240:243]
s_waitcnt lgkmcnt(3)
v_mul_f32 v213, v56, v213
v_mul_f32 v214, v56, v214
v_mfma_f32_16x16x32_bf16 v[244:247], v[92:95], v[184:187], v[244:247]
v_mul_f32 v215, v56, v215
v_cvt_pk_bf16_f32 v212, v212, v213
v_mfma_f32_16x16x32_bf16 v[248:251], v[92:95], v[188:191], v[248:251]
v_cvt_pk_bf16_f32 v213, v214, v215
v_mul_f32 v216, v56, v216
v_mfma_f32_16x16x32_bf16 v[252:255], v[92:95], v[192:195], v[252:255]
s_waitcnt lgkmcnt(1)
buffer_load_dwordx4 v12, s[20:23], s46 offen offset:3072 lds
v_mfma_f32_16x16x32_bf16 v[244:247], v[108:111], v[196:199], v[244:247]
ds_write_b64 v35, v[212:213] offset:2048
v_mfma_f32_16x16x32_bf16 v[248:251], v[108:111], v[200:203], v[248:251]
v_mul_f32 v217, v56, v217
v_mul_f32 v218, v56, v218
v_mfma_f32_16x16x32_bf16 v[252:255], v[108:111], v[204:207], v[252:255]
v_mul_f32 v219, v56, v219
v_cvt_pk_bf16_f32 v216, v216, v217
v_cvt_pk_bf16_f32 v217, v218, v219
ds_write_b64 v35, v[216:217] offset:4096
v_mul_f32 v220, v56, v220
v_mul_f32 v221, v56, v221
v_mul_f32 v222, v56, v222
v_mul_f32 v223, v56, v223
v_cvt_pk_bf16_f32 v220, v220, v221
v_cvt_pk_bf16_f32 v221, v222, v223
ds_write_b64 v35, v[220:221] offset:512
v_mul_f32 v224, v56, v224
v_mul_f32 v225, v56, v225
v_mul_f32 v226, v56, v226
v_mul_f32 v227, v56, v227
v_cvt_pk_bf16_f32 v224, v224, v225
v_cvt_pk_bf16_f32 v225, v226, v227
ds_write_b64 v35, v[224:225] offset:2560
v_mul_f32 v228, v56, v228
v_mul_f32 v229, v56, v229
v_mul_f32 v230, v56, v230
v_mul_f32 v231, v56, v231
v_cvt_pk_bf16_f32 v228, v228, v229
v_cvt_pk_bf16_f32 v229, v230, v231
ds_write_b64 v35, v[228:229] offset:4608
v_mul_f32 v232, v56, v232
v_mul_f32 v233, v56, v233
v_mul_f32 v234, v56, v234
v_mul_f32 v235, v56, v235
v_cvt_pk_bf16_f32 v232, v232, v233
v_cvt_pk_bf16_f32 v233, v234, v235
ds_write_b64 v35, v[232:233] offset:1024
v_mul_f32 v236, v56, v236
v_mul_f32 v237, v56, v237
v_mul_f32 v238, v56, v238
v_mul_f32 v239, v56, v239
v_cvt_pk_bf16_f32 v236, v236, v237
v_cvt_pk_bf16_f32 v237, v238, v239
ds_write_b64 v35, v[236:237] offset:3072
v_mul_f32 v240, v56, v240
v_mul_f32 v241, v56, v241
v_mul_f32 v242, v56, v242
v_mul_f32 v243, v56, v243
v_cvt_pk_bf16_f32 v240, v240, v241
v_cvt_pk_bf16_f32 v241, v242, v243
ds_write_b64 v35, v[240:241] offset:5120
s_add_u32 m0, s54, 0
s_nop 0
buffer_load_dwordx4 v9, s[20:23], s47 offen offset:0 lds
v_pk_mul_f32 v[244:245], v[244:245], v[56:57] op_sel_hi:[1,0]
v_pk_mul_f32 v[246:247], v[246:247], v[56:57] op_sel_hi:[1,0]
v_cvt_pk_bf16_f32 v244, v244, v245
v_cvt_pk_bf16_f32 v245, v246, v247
ds_write_b64 v35, v[244:245] offset:1536
buffer_load_dwordx4 v10, s[20:23], s47 offen offset:1024 lds
v_pk_mul_f32 v[248:249], v[248:249], v[56:57] op_sel_hi:[1,0]
v_pk_mul_f32 v[250:251], v[250:251], v[56:57] op_sel_hi:[1,0]
v_cvt_pk_bf16_f32 v248, v248, v249
v_cvt_pk_bf16_f32 v249, v250, v251
ds_write_b64 v35, v[248:249] offset:3584
buffer_load_dwordx4 v11, s[20:23], s47 offen offset:2048 lds
v_pk_mul_f32 v[252:253], v[252:253], v[56:57] op_sel_hi:[1,0]
v_pk_mul_f32 v[254:255], v[254:255], v[56:57] op_sel_hi:[1,0]
v_cvt_pk_bf16_f32 v252, v252, v253
v_cvt_pk_bf16_f32 v253, v254, v255
ds_write_b64 v35, v[252:253] offset:5632
buffer_load_dwordx4 v12, s[20:23], s47 offen offset:3072 lds
s_sub_u32 s8, s3, 98304
v_readfirstlane_b32 s3, v54
s_lshl_b32 s9, s1, 7
s_add_u32 s9, s9, s8
s_mul_i32 s13, s3, 0x9e3779b1
s_add_u32 s13, s13, 0x7f4a7c15
s_and_b32 s13, s13, -4
s_add_u32 s3, s3, 1
s_waitcnt lgkmcnt(0)
s_barrier
ds_read_b128 a[0:3], v36 offset:0
ds_read_b128 a[4:7], v36 offset:512
ds_read_b128 a[8:11], v36 offset:1024
ds_read_b128 a[12:15], v36 offset:1536
ds_read_b128 a[16:19], v36 offset:8192
ds_read_b128 a[20:23], v36 offset:8704
ds_read_b128 a[24:27], v36 offset:9216
ds_read_b128 a[28:31], v36 offset:9728
s_add_u32 m0, s54, 4096
s_nop 0
buffer_load_dwordx4 v9, s[20:23], s48 offen offset:0 lds
buffer_load_dwordx4 v10, s[20:23], s48 offen offset:1024 lds
buffer_load_dwordx4 v11, s[20:23], s48 offen offset:2048 lds
buffer_load_dwordx4 v12, s[20:23], s48 offen offset:3072 lds
s_waitcnt vmcnt(16)
ds_read_b128 a[96:99], v18 offset:32768
ds_read_b128 a[100:103], v19 offset:32768
ds_read_b128 a[104:107], v20 offset:32768
ds_read_b128 a[108:111], v21 offset:32768
ds_read_b128 a[112:115], v22 offset:32768
ds_read_b128 a[116:119], v23 offset:32768
ds_read_b128 a[120:123], v24 offset:32768
ds_read_b128 a[124:127], v25 offset:32768
s_waitcnt lgkmcnt(7)
v_mfma_f32_32x32x16_bf16 v[64:79], a[96:99], a[0:3], 0
s_waitcnt lgkmcnt(6)
s_add_u32 m0, s54, 65536
ds_read_b128 a[32:35], v37 offset:4096
ds_read_b128 a[36:39], v37 offset:4608
v_mfma_f32_32x32x16_bf16 v[64:79], a[100:103], a[4:7], v[64:79]
s_waitcnt lgkmcnt(7)
ds_read_b128 a[40:43], v37 offset:5120
ds_read_b128 a[44:47], v37 offset:5632
buffer_load_dwordx4 v9, s[20:23], s49 offen offset:0 lds
v_add_u32 v18, 4294901760, v18
v_add_u32 v19, 4294901760, v19
v_add_u32 v20, 4294901760, v20
v_mfma_f32_32x32x16_bf16 v[64:79], a[104:107], a[8:11], v[64:79]
s_waitcnt lgkmcnt(8)
ds_read_b128 a[48:51], v37 offset:12288
ds_read_b128 a[52:55], v37 offset:12800
v_add_u32 v21, 4294901760, v21
v_add_u32 v22, 4294901760, v22
v_add_u32 v23, 4294901760, v23
v_add_u32 v24, 4294901760, v24
v_add_u32 v25, 4294901760, v25
v_mfma_f32_32x32x16_bf16 v[64:79], a[108:111], a[12:15], v[64:79]
s_waitcnt lgkmcnt(9)
ds_read_b128 a[56:59], v37 offset:13312
ds_read_b128 a[60:63], v37 offset:13824
v_mfma_f32_32x32x16_bf16 v[64:79], a[112:115], a[16:19], v[64:79]
s_waitcnt lgkmcnt(10)
ds_read_b128 a[64:67], v36 offset:18432
ds_read_b128 a[68:71], v36 offset:18944
buffer_load_dwordx4 v10, s[20:23], s49 offen offset:1024 lds
v_mfma_f32_32x32x16_bf16 v[64:79], a[116:119], a[20:23], v[64:79]
s_waitcnt lgkmcnt(11)
ds_read_b128 a[72:75], v36 offset:19456
ds_read_b128 a[76:79], v36 offset:19968
v_mfma_f32_32x32x16_bf16 v[64:79], a[120:123], a[24:27], v[64:79]
s_waitcnt lgkmcnt(12)
ds_read_b128 a[80:83], v36 offset:26624
ds_read_b128 a[84:87], v36 offset:27136
v_mfma_f32_32x32x16_bf16 v[64:79], a[124:127], a[28:31], v[64:79]
s_waitcnt lgkmcnt(13)
ds_read_b128 a[88:91], v36 offset:27648
ds_read_b128 a[92:95], v36 offset:28160
buffer_load_dwordx4 v11, s[20:23], s49 offen offset:2048 lds
v_mfma_f32_32x32x16_bf16 v[80:95], a[96:99], a[32:35], 0
s_waitcnt lgkmcnt(14)
v_mfma_f32_32x32x16_bf16 v[80:95], a[100:103], a[36:39], v[80:95]
s_waitcnt lgkmcnt(13)
s_nop 3
v_exp_f32 v64, v64
v_exp_f32 v65, v65
v_exp_f32 v66, v66
v_mfma_f32_32x32x16_bf16 v[80:95], a[104:107], a[40:43], v[80:95]
s_waitcnt lgkmcnt(12)
buffer_load_dwordx4 v12, s[20:23], s49 offen offset:3072 lds
v_exp_f32 v67, v67
v_add_f32 v40, v64, v65
v_cvt_pk_bf16_f32 v64, v64, v65
v_exp_f32 v68, v68
v_mfma_f32_32x32x16_bf16 v[80:95], a[108:111], a[44:47], v[80:95]
s_waitcnt lgkmcnt(11)
v_exp_f32 v69, v69
v_add_f32 v40, v40, v66
v_add_f32 v40, v40, v67
v_cvt_pk_bf16_f32 v65, v66, v67
v_exp_f32 v70, v70
v_mfma_f32_32x32x16_bf16 v[80:95], a[112:115], a[48:51], v[80:95]
s_waitcnt lgkmcnt(10)
s_add_u32 m0, s54, 69632
v_exp_f32 v71, v71
v_add_f32 v40, v40, v68
v_add_f32 v40, v40, v69
v_cvt_pk_bf16_f32 v66, v68, v69
v_add_f32 v40, v40, v70
v_add_f32 v40, v40, v71
v_cvt_pk_bf16_f32 v67, v70, v71
v_mfma_f32_32x32x16_bf16 v[80:95], a[116:119], a[52:55], v[80:95]
s_waitcnt lgkmcnt(9)
buffer_load_dwordx4 v9, s[20:23], s50 offen offset:0 lds
v_exp_f32 v72, v72
v_exp_f32 v73, v73
v_mfma_f32_32x32x16_bf16 v[80:95], a[120:123], a[56:59], v[80:95]
s_waitcnt lgkmcnt(8)
ds_write_b128 v27, v[64:67] offset:0
v_exp_f32 v74, v74
v_mfma_f32_32x32x16_bf16 v[80:95], a[124:127], a[60:63], v[80:95]
s_waitcnt lgkmcnt(8)
v_exp_f32 v75, v75
v_add_f32 v40, v40, v72
v_add_f32 v40, v40, v73
v_cvt_pk_bf16_f32 v68, v72, v73
v_exp_f32 v76, v76
v_exp_f32 v77, v77
v_mfma_f32_32x32x16_bf16 v[96:111], a[96:99], a[64:67], 0
s_waitcnt lgkmcnt(7)
buffer_load_dwordx4 v10, s[20:23], s50 offen offset:1024 lds
v_add_f32 v40, v40, v74
v_add_f32 v40, v40, v75
v_cvt_pk_bf16_f32 v69, v74, v75
v_exp_f32 v78, v78
v_mfma_f32_32x32x16_bf16 v[96:111], a[100:103], a[68:71], v[96:111]
s_waitcnt lgkmcnt(6)
v_exp_f32 v79, v79
v_add_f32 v40, v40, v76
v_add_f32 v40, v40, v77
v_cvt_pk_bf16_f32 v70, v76, v77
v_add_f32 v40, v40, v78
v_add_f32 v40, v40, v79
v_cvt_pk_bf16_f32 v71, v78, v79
v_mfma_f32_32x32x16_bf16 v[96:111], a[104:107], a[72:75], v[96:111]
s_waitcnt lgkmcnt(5)
s_waitcnt vmcnt(14)
ds_read_b128 a[128:131], v18 offset:32768
ds_read_b128 a[132:135], v19 offset:32768
v_exp_f32 v80, v80
v_exp_f32 v81, v81
v_mfma_f32_32x32x16_bf16 v[96:111], a[108:111], a[76:79], v[96:111]
s_waitcnt lgkmcnt(6)
ds_read_b128 a[136:139], v20 offset:32768
ds_read_b128 a[140:143], v21 offset:32768
buffer_load_dwordx4 v11, s[20:23], s50 offen offset:2048 lds
v_exp_f32 v82, v82
v_exp_f32 v83, v83
v_mfma_f32_32x32x16_bf16 v[96:111], a[112:115], a[80:83], v[96:111]
s_waitcnt lgkmcnt(7)
ds_read_b128 a[144:147], v22 offset:32768
ds_read_b128 a[148:151], v23 offset:32768
v_add_f32 v41, v80, v81
v_cvt_pk_bf16_f32 v80, v80, v81
v_exp_f32 v84, v84
v_mfma_f32_32x32x16_bf16 v[96:111], a[116:119], a[84:87], v[96:111]
s_waitcnt lgkmcnt(8)
ds_read_b128 a[152:155], v24 offset:32768
ds_read_b128 a[156:159], v25 offset:32768
v_exp_f32 v85, v85
v_add_f32 v41, v41, v82
v_add_f32 v41, v41, v83
v_cvt_pk_bf16_f32 v81, v82, v83
v_exp_f32 v86, v86
v_mfma_f32_32x32x16_bf16 v[96:111], a[120:123], a[88:91], v[96:111]
s_waitcnt lgkmcnt(9)
buffer_load_dwordx4 v12, s[20:23], s50 offen offset:3072 lds
v_exp_f32 v87, v87
v_add_f32 v41, v41, v84
v_add_f32 v41, v41, v85
v_cvt_pk_bf16_f32 v82, v84, v85
v_mfma_f32_32x32x16_bf16 v[96:111], a[124:127], a[92:95], v[96:111]
s_waitcnt lgkmcnt(7)
ds_write_b128 v27, v[68:71] offset:3072
v_add_f32 v41, v41, v86
v_add_f32 v41, v41, v87
v_cvt_pk_bf16_f32 v83, v86, v87
v_mfma_f32_32x32x16_bf16 v[112:127], a[128:131], a[0:3], 0
s_waitcnt lgkmcnt(7)
s_add_u32 m0, s54, 32768
s_waitcnt lgkmcnt(1)
ds_write_b128 v27, v[80:83] offset:1024
v_mfma_f32_32x32x16_bf16 v[112:127], a[132:135], a[4:7], v[112:127]
buffer_load_dwordx4 v13, s[24:27], s43 offen offset:0 lds
v_exp_f32 v88, v88
v_exp_f32 v89, v89
v_mfma_f32_32x32x16_bf16 v[112:127], a[136:139], a[8:11], v[112:127]
s_barrier
v_mfma_f32_32x32x16_bf16 v[112:127], a[140:143], a[12:15], v[112:127]
v_exp_f32 v90, v90
v_exp_f32 v91, v91
v_add_f32 v41, v41, v88
v_add_f32 v41, v41, v89
v_cvt_pk_bf16_f32 v84, v88, v89
v_mfma_f32_32x32x16_bf16 v[112:127], a[144:147], a[16:19], v[112:127]
buffer_load_dwordx4 v13, s[24:27], s43 offen offset:1024 lds
v_exp_f32 v92, v92
v_exp_f32 v93, v93
v_add_f32 v41, v41, v90
v_add_f32 v41, v41, v91
v_mfma_f32_32x32x16_bf16 v[112:127], a[148:151], a[20:23], v[112:127]
v_cvt_pk_bf16_f32 v85, v90, v91
v_exp_f32 v94, v94
v_exp_f32 v95, v95
v_add_f32 v41, v41, v92
v_add_f32 v41, v41, v93
v_mfma_f32_32x32x16_bf16 v[112:127], a[152:155], a[24:27], v[112:127]
v_cvt_pk_bf16_f32 v86, v92, v93
v_add_f32 v41, v41, v94
v_add_f32 v41, v41, v95
v_cvt_pk_bf16_f32 v87, v94, v95
v_exp_f32 v96, v96
v_exp_f32 v97, v97
v_mfma_f32_32x32x16_bf16 v[112:127], a[156:159], a[28:31], v[112:127]
buffer_load_dwordx4 v13, s[24:27], s43 offen offset:2048 lds
v_exp_f32 v98, v98
v_exp_f32 v99, v99
v_add_f32 v42, v96, v97
v_mfma_f32_32x32x16_bf16 v[128:143], a[128:131], a[32:35], 0
ds_write_b128 v27, v[84:87] offset:4096
v_cvt_pk_bf16_f32 v96, v96, v97
v_mfma_f32_32x32x16_bf16 v[128:143], a[132:135], a[36:39], v[128:143]
v_exp_f32 v100, v100
v_exp_f32 v101, v101
v_add_f32 v42, v42, v98
v_add_f32 v42, v42, v99
v_cvt_pk_bf16_f32 v97, v98, v99
v_exp_f32 v102, v102
v_mfma_f32_32x32x16_bf16 v[128:143], a[136:139], a[40:43], v[128:143]
buffer_load_dwordx4 v13, s[24:27], s43 offen offset:3072 lds
v_exp_f32 v103, v103
v_add_f32 v42, v42, v100
v_add_f32 v42, v42, v101
v_cvt_pk_bf16_f32 v98, v100, v101
v_mfma_f32_32x32x16_bf16 v[128:143], a[140:143], a[44:47], v[128:143]
v_add_f32 v42, v42, v102
v_add_f32 v42, v42, v103
v_cvt_pk_bf16_f32 v99, v102, v103
v_exp_f32 v104, v104
v_exp_f32 v105, v105
v_mfma_f32_32x32x16_bf16 v[128:143], a[144:147], a[48:51], v[128:143]
s_add_u32 m0, s54, 36864
ds_write_b128 v27, v[96:99] offset:2048
v_exp_f32 v106, v106
v_mfma_f32_32x32x16_bf16 v[128:143], a[148:151], a[52:55], v[128:143]
buffer_load_dwordx4 v13, s[24:27], s44 offen offset:0 lds
v_exp_f32 v107, v107
v_add_f32 v42, v42, v104
v_add_f32 v42, v42, v105
v_cvt_pk_bf16_f32 v100, v104, v105
v_mfma_f32_32x32x16_bf16 v[128:143], a[152:155], a[56:59], v[128:143]
v_exp_f32 v108, v108
v_exp_f32 v109, v109
v_add_f32 v42, v42, v106
v_add_f32 v42, v42, v107
v_cvt_pk_bf16_f32 v101, v106, v107
v_mfma_f32_32x32x16_bf16 v[128:143], a[156:159], a[60:63], v[128:143]
v_exp_f32 v110, v110
v_exp_f32 v111, v111
v_add_f32 v42, v42, v108
v_add_f32 v42, v42, v109
v_cvt_pk_bf16_f32 v102, v108, v109
v_add_f32 v42, v42, v110
v_add_f32 v42, v42, v111
v_mfma_f32_32x32x16_bf16 v[144:159], a[128:131], a[64:67], 0
buffer_load_dwordx4 v13, s[24:27], s44 offen offset:1024 lds
v_cvt_pk_bf16_f32 v103, v110, v111
v_exp_f32 v112, v112
v_exp_f32 v113, v113
v_mfma_f32_32x32x16_bf16 v[144:159], a[132:135], a[68:71], v[144:159]
v_exp_f32 v114, v114
v_exp_f32 v115, v115
v_add_f32 v40, v40, v112
v_add_f32 v40, v40, v113
v_cvt_pk_bf16_f32 v112, v112, v113
v_mfma_f32_32x32x16_bf16 v[144:159], a[136:139], a[72:75], v[144:159]
s_waitcnt vmcnt(14)
ds_read_b128 a[160:163], v18 offset:0
ds_read_b128 a[164:167], v19 offset:0
v_exp_f32 v116, v116
v_exp_f32 v117, v117
v_add_f32 v40, v40, v114
v_mfma_f32_32x32x16_bf16 v[144:159], a[140:143], a[76:79], v[144:159]
ds_read_b128 a[168:171], v20 offset:0
ds_read_b128 a[172:175], v21 offset:0
buffer_load_dwordx4 v13, s[24:27], s44 offen offset:2048 lds
v_add_f32 v40, v40, v115
v_cvt_pk_bf16_f32 v113, v114, v115
v_exp_f32 v118, v118
v_mfma_f32_32x32x16_bf16 v[144:159], a[144:147], a[80:83], v[144:159]
ds_read_b128 a[176:179], v22 offset:0
ds_read_b128 a[180:183], v23 offset:0
v_exp_f32 v119, v119
v_add_f32 v40, v40, v116
v_add_f32 v40, v40, v117
v_cvt_pk_bf16_f32 v114, v116, v117
v_mfma_f32_32x32x16_bf16 v[144:159], a[148:151], a[84:87], v[144:159]
ds_read_b128 a[184:187], v24 offset:0
ds_read_b128 a[188:191], v25 offset:0
v_add_f32 v40, v40, v118
v_add_f32 v40, v40, v119
v_cvt_pk_bf16_f32 v115, v118, v119
v_exp_f32 v120, v120
v_mfma_f32_32x32x16_bf16 v[144:159], a[152:155], a[88:91], v[144:159]
buffer_load_dwordx4 v13, s[24:27], s44 offen offset:3072 lds
v_exp_f32 v121, v121
v_exp_f32 v122, v122
v_exp_f32 v123, v123
v_mfma_f32_32x32x16_bf16 v[144:159], a[156:159], a[92:95], v[144:159]
s_waitcnt lgkmcnt(7)
ds_write_b128 v27, v[100:103] offset:5120
v_add_f32 v40, v40, v120
v_add_f32 v40, v40, v121
v_mfma_f32_32x32x16_bf16 v[160:175], a[160:163], a[0:3], 0
s_waitcnt lgkmcnt(7)
s_add_u32 m0, s54, 0
s_waitcnt lgkmcnt(1)
ds_write_b128 v27, v[112:115] offset:32768
v_cvt_pk_bf16_f32 v116, v120, v121
v_mfma_f32_32x32x16_bf16 v[160:175], a[164:167], a[4:7], v[160:175]
buffer_load_dwordx4 v13, s[24:27], s45 offen offset:0 lds
v_exp_f32 v124, v124
v_exp_f32 v125, v125
v_add_f32 v40, v40, v122
v_mfma_f32_32x32x16_bf16 v[160:175], a[168:171], a[8:11], v[160:175]
v_add_f32 v40, v40, v123
v_cvt_pk_bf16_f32 v117, v122, v123
v_exp_f32 v126, v126
v_exp_f32 v127, v127
v_add_f32 v40, v40, v124
v_add_f32 v40, v40, v125
v_mfma_f32_32x32x16_bf16 v[160:175], a[172:175], a[12:15], v[160:175]
v_cvt_pk_bf16_f32 v118, v124, v125
v_add_f32 v40, v40, v126
v_add_f32 v40, v40, v127
v_cvt_pk_bf16_f32 v119, v126, v127
v_exp_f32 v128, v128
v_mfma_f32_32x32x16_bf16 v[160:175], a[176:179], a[16:19], v[160:175]
buffer_load_dwordx4 v13, s[24:27], s45 offen offset:1024 lds
v_exp_f32 v129, v129
v_exp_f32 v130, v130
v_exp_f32 v131, v131
v_add_f32 v41, v41, v128
v_mfma_f32_32x32x16_bf16 v[160:175], a[180:183], a[20:23], v[160:175]
ds_write_b128 v27, v[116:119] offset:35840
v_add_f32 v41, v41, v129
v_cvt_pk_bf16_f32 v128, v128, v129
v_mfma_f32_32x32x16_bf16 v[160:175], a[184:187], a[24:27], v[160:175]
v_exp_f32 v132, v132
v_exp_f32 v133, v133
v_add_f32 v41, v41, v130
v_add_f32 v41, v41, v131
v_cvt_pk_bf16_f32 v129, v130, v131
v_mfma_f32_32x32x16_bf16 v[160:175], a[188:191], a[28:31], v[160:175]
buffer_load_dwordx4 v13, s[24:27], s45 offen offset:2048 lds
v_exp_f32 v134, v134
v_exp_f32 v135, v135
v_add_f32 v41, v41, v132
v_add_f32 v41, v41, v133
v_mfma_f32_32x32x16_bf16 v[176:191], a[160:163], a[32:35], 0
v_cvt_pk_bf16_f32 v130, v132, v133
v_add_f32 v41, v41, v134
v_add_f32 v41, v41, v135
v_cvt_pk_bf16_f32 v131, v134, v135
v_exp_f32 v136, v136
v_mfma_f32_32x32x16_bf16 v[176:191], a[164:167], a[36:39], v[176:191]
ds_write_b128 v27, v[128:131] offset:33792
v_exp_f32 v137, v137
v_exp_f32 v138, v138
v_mfma_f32_32x32x16_bf16 v[176:191], a[168:171], a[40:43], v[176:191]
buffer_load_dwordx4 v13, s[24:27], s45 offen offset:3072 lds
v_exp_f32 v139, v139
v_add_f32 v41, v41, v136
v_add_f32 v41, v41, v137
v_cvt_pk_bf16_f32 v132, v136, v137
v_mfma_f32_32x32x16_bf16 v[176:191], a[172:175], a[44:47], v[176:191]
v_exp_f32 v140, v140
v_exp_f32 v141, v141
v_add_f32 v41, v41, v138
v_add_f32 v41, v41, v139
v_cvt_pk_bf16_f32 v133, v138, v139
v_mfma_f32_32x32x16_bf16 v[176:191], a[176:179], a[48:51], v[176:191]
s_add_u32 m0, s54, 4096
v_exp_f32 v142, v142
v_exp_f32 v143, v143
v_add_f32 v41, v41, v140
v_add_f32 v41, v41, v141
v_cvt_pk_bf16_f32 v134, v140, v141
v_mfma_f32_32x32x16_bf16 v[176:191], a[180:183], a[52:55], v[176:191]
buffer_load_dwordx4 v13, s[24:27], s46 offen offset:0 lds
v_add_f32 v41, v41, v142
v_add_f32 v41, v41, v143
v_cvt_pk_bf16_f32 v135, v142, v143
v_add_u32 v18, 65536, v18
v_add_u32 v19, 65536, v19
v_add_u32 v20, 65536, v20
v_mfma_f32_32x32x16_bf16 v[176:191], a[184:187], a[56:59], v[176:191]
ds_write_b128 v27, v[132:135] offset:36864
v_add_u32 v21, 65536, v21
v_add_u32 v22, 65536, v22
v_mfma_f32_32x32x16_bf16 v[176:191], a[188:191], a[60:63], v[176:191]
v_add_u32 v23, 65536, v23
v_add_u32 v24, 65536, v24
v_add_u32 v25, 65536, v25
v_exp_f32 v144, v144
v_exp_f32 v145, v145
v_mfma_f32_32x32x16_bf16 v[192:207], a[160:163], a[64:67], 0
buffer_load_dwordx4 v13, s[24:27], s46 offen offset:1024 lds
v_exp_f32 v146, v146
v_exp_f32 v147, v147
v_add_f32 v42, v42, v144
v_add_f32 v42, v42, v145
v_mfma_f32_32x32x16_bf16 v[192:207], a[164:167], a[68:71], v[192:207]
v_cvt_pk_bf16_f32 v144, v144, v145
v_exp_f32 v148, v148
v_exp_f32 v149, v149
v_add_f32 v42, v42, v146
v_add_f32 v42, v42, v147
v_mfma_f32_32x32x16_bf16 v[192:207], a[168:171], a[72:75], v[192:207]
s_waitcnt vmcnt(14)
ds_read_b128 a[192:195], v18 offset:0
ds_read_b128 a[196:199], v19 offset:0
v_cvt_pk_bf16_f32 v145, v146, v147
v_exp_f32 v150, v150
v_exp_f32 v151, v151
v_mfma_f32_32x32x16_bf16 v[192:207], a[172:175], a[76:79], v[192:207]
ds_read_b128 a[200:203], v20 offset:0
ds_read_b128 a[204:207], v21 offset:0
buffer_load_dwordx4 v13, s[24:27], s46 offen offset:2048 lds
v_add_f32 v42, v42, v148
v_add_f32 v42, v42, v149
v_cvt_pk_bf16_f32 v146, v148, v149
v_mfma_f32_32x32x16_bf16 v[192:207], a[176:179], a[80:83], v[192:207]
ds_read_b128 a[208:211], v22 offset:0
ds_read_b128 a[212:215], v23 offset:0
v_add_f32 v42, v42, v150
v_add_f32 v42, v42, v151
v_cvt_pk_bf16_f32 v147, v150, v151
v_exp_f32 v152, v152
v_mfma_f32_32x32x16_bf16 v[192:207], a[180:183], a[84:87], v[192:207]
ds_read_b128 a[216:219], v24 offset:0
ds_read_b128 a[220:223], v25 offset:0
v_exp_f32 v153, v153
v_exp_f32 v154, v154
v_exp_f32 v155, v155
v_mfma_f32_32x32x16_bf16 v[192:207], a[184:187], a[88:91], v[192:207]
buffer_load_dwordx4 v13, s[24:27], s46 offen offset:3072 lds
v_add_f32 v42, v42, v152
v_add_f32 v42, v42, v153
v_cvt_pk_bf16_f32 v148, v152, v153
v_exp_f32 v156, v156
v_mfma_f32_32x32x16_bf16 v[192:207], a[188:191], a[92:95], v[192:207]
s_waitcnt lgkmcnt(7)
ds_write_b128 v27, v[144:147] offset:34816
v_exp_f32 v157, v157
v_add_f32 v42, v42, v154
v_mfma_f32_32x32x16_bf16 v[64:79], a[192:195], a[0:3], 0
s_waitcnt lgkmcnt(7)
s_add_u32 m0, s54, 65536
s_waitcnt lgkmcnt(1)
v_add_f32 v42, v42, v155
v_cvt_pk_bf16_f32 v149, v154, v155
v_exp_f32 v158, v158
v_exp_f32 v159, v159
v_mfma_f32_32x32x16_bf16 v[64:79], a[196:199], a[4:7], v[64:79]
buffer_load_dwordx4 v13, s[24:27], s47 offen offset:0 lds
v_add_f32 v42, v42, v156
v_add_f32 v42, v42, v157
v_cvt_pk_bf16_f32 v150, v156, v157
v_add_f32 v42, v42, v158
v_add_f32 v42, v42, v159
v_mfma_f32_32x32x16_bf16 v[64:79], a[200:203], a[8:11], v[64:79]
v_cvt_pk_bf16_f32 v151, v158, v159
v_exp_f32 v160, v160
v_exp_f32 v161, v161
v_exp_f32 v162, v162
v_mfma_f32_32x32x16_bf16 v[64:79], a[204:207], a[12:15], v[64:79]
ds_write_b128 v27, v[148:151] offset:37888
v_exp_f32 v163, v163
v_add_f32 v40, v40, v160
v_mfma_f32_32x32x16_bf16 v[64:79], a[208:211], a[16:19], v[64:79]
buffer_load_dwordx4 v13, s[24:27], s47 offen offset:1024 lds
v_add_f32 v40, v40, v161
v_cvt_pk_bf16_f32 v160, v160, v161
v_exp_f32 v164, v164
v_mfma_f32_32x32x16_bf16 v[64:79], a[212:215], a[20:23], v[64:79]
v_exp_f32 v165, v165
v_add_f32 v40, v40, v162
v_add_f32 v40, v40, v163
v_cvt_pk_bf16_f32 v161, v162, v163
v_exp_f32 v166, v166
v_exp_f32 v167, v167
v_mfma_f32_32x32x16_bf16 v[64:79], a[216:219], a[24:27], v[64:79]
v_add_f32 v40, v40, v164
v_add_f32 v40, v40, v165
v_cvt_pk_bf16_f32 v162, v164, v165
v_add_f32 v40, v40, v166
v_add_f32 v40, v40, v167
v_cvt_pk_bf16_f32 v163, v166, v167
v_mfma_f32_32x32x16_bf16 v[64:79], a[220:223], a[28:31], v[64:79]
buffer_load_dwordx4 v13, s[24:27], s47 offen offset:2048 lds
v_exp_f32 v168, v168
v_exp_f32 v169, v169
v_exp_f32 v170, v170
v_mfma_f32_32x32x16_bf16 v[80:95], a[192:195], a[32:35], 0
v_exp_f32 v171, v171
v_add_f32 v40, v40, v168
v_add_f32 v40, v40, v169
v_cvt_pk_bf16_f32 v164, v168, v169
v_exp_f32 v172, v172
v_mfma_f32_32x32x16_bf16 v[80:95], a[196:199], a[36:39], v[80:95]
v_exp_f32 v173, v173
v_add_f32 v40, v40, v170
v_add_f32 v40, v40, v171
v_cvt_pk_bf16_f32 v165, v170, v171
v_exp_f32 v174, v174
v_exp_f32 v175, v175
v_mfma_f32_32x32x16_bf16 v[80:95], a[200:203], a[40:43], v[80:95]
buffer_load_dwordx4 v13, s[24:27], s47 offen offset:3072 lds
v_add_f32 v40, v40, v172
v_add_f32 v40, v40, v173
v_cvt_pk_bf16_f32 v166, v172, v173
v_add_f32 v40, v40, v174
v_add_f32 v40, v40, v175
v_mfma_f32_32x32x16_bf16 v[80:95], a[204:207], a[44:47], v[80:95]
v_cvt_pk_bf16_f32 v167, v174, v175
v_exp_f32 v176, v176
v_exp_f32 v177, v177
v_exp_f32 v178, v178
v_mfma_f32_32x32x16_bf16 v[80:95], a[208:211], a[48:51], v[80:95]
s_add_u32 m0, s54, 69632
v_exp_f32 v179, v179
v_add_f32 v41, v41, v176
v_add_f32 v41, v41, v177
v_cvt_pk_bf16_f32 v176, v176, v177
v_exp_f32 v180, v180
v_mfma_f32_32x32x16_bf16 v[80:95], a[212:215], a[52:55], v[80:95]
buffer_load_dwordx4 v13, s[24:27], s48 offen offset:0 lds
v_exp_f32 v181, v181
v_add_f32 v41, v41, v178
v_add_f32 v41, v41, v179
v_cvt_pk_bf16_f32 v177, v178, v179
v_mfma_f32_32x32x16_bf16 v[80:95], a[216:219], a[56:59], v[80:95]
v_exp_f32 v182, v182
v_exp_f32 v183, v183
v_add_f32 v41, v41, v180
v_add_f32 v41, v41, v181
v_cvt_pk_bf16_f32 v178, v180, v181
v_add_f32 v41, v41, v182
v_mfma_f32_32x32x16_bf16 v[80:95], a[220:223], a[60:63], v[80:95]
v_add_f32 v41, v41, v183
v_cvt_pk_bf16_f32 v179, v182, v183
v_exp_f32 v184, v184
v_exp_f32 v185, v185
v_exp_f32 v186, v186
v_mfma_f32_32x32x16_bf16 v[96:111], a[192:195], a[64:67], 0
buffer_load_dwordx4 v13, s[24:27], s48 offen offset:1024 lds
v_exp_f32 v187, v187
v_add_f32 v41, v41, v184
v_add_f32 v41, v41, v185
v_cvt_pk_bf16_f32 v180, v184, v185
v_mfma_f32_32x32x16_bf16 v[96:111], a[196:199], a[68:71], v[96:111]
v_exp_f32 v188, v188
v_exp_f32 v189, v189
v_add_f32 v41, v41, v186
v_add_f32 v41, v41, v187
v_cvt_pk_bf16_f32 v181, v186, v187
v_mfma_f32_32x32x16_bf16 v[96:111], a[200:203], a[72:75], v[96:111]
v_exp_f32 v190, v190
v_exp_f32 v191, v191
v_add_f32 v41, v41, v188
v_add_f32 v41, v41, v189
v_cvt_pk_bf16_f32 v182, v188, v189
v_add_f32 v41, v41, v190
v_mfma_f32_32x32x16_bf16 v[96:111], a[204:207], a[76:79], v[96:111]
s_waitcnt vmcnt(14) lgkmcnt(0)
s_barrier
v_mfma_f32_32x32x16_bf16 v[96:111], a[208:211], a[80:83], v[96:111]
ds_read_b64_tr_b16 a[224:225], v31 offset:32768
ds_read_b64_tr_b16 a[226:227], v31 offset:34816
ds_read_b128 a[228:231], v27 offset:0
buffer_load_dwordx4 v13, s[24:27], s48 offen offset:2048 lds
v_add_f32 v41, v41, v191
v_cvt_pk_bf16_f32 v183, v190, v191
v_mfma_f32_32x32x16_bf16 v[96:111], a[212:215], a[84:87], v[96:111]
ds_read_b128 a[232:235], v27 offset:1024
ds_read_b128 a[236:239], v27 offset:2048
v_exp_f32 v192, v192
v_exp_f32 v193, v193
v_exp_f32 v194, v194
v_mfma_f32_32x32x16_bf16 v[96:111], a[216:219], a[88:91], v[96:111]
ds_read_b64_tr_b16 a[240:241], v31 offset:36864
ds_read_b64_tr_b16 a[242:243], v31 offset:38912
ds_read_b128 a[244:247], v27 offset:3072
v_exp_f32 v195, v195
v_add_f32 v42, v42, v192
v_add_f32 v42, v42, v193
v_mfma_f32_32x32x16_bf16 v[96:111], a[220:223], a[92:95], v[96:111]
s_waitcnt lgkmcnt(5)
ds_read_b128 a[248:251], v27 offset:4096
ds_read_b128 a[252:255], v27 offset:5120
buffer_load_dwordx4 v13, s[24:27], s48 offen offset:3072 lds
v_cvt_pk_bf16_f32 v192, v192, v193
v_exp_f32 v196, v196
v_mfma_f32_32x32x16_bf16 v[208:223], a[224:227], a[228:231], 0
s_waitcnt lgkmcnt(6)
ds_read_b64_tr_b16 a[96:97], v32 offset:32768
ds_read_b64_tr_b16 a[98:99], v32 offset:34816
ds_read_b128 a[100:103], v28 offset:0
v_exp_f32 v197, v197
v_add_f32 v42, v42, v194
v_add_f32 v42, v42, v195
v_cvt_pk_bf16_f32 v193, v194, v195
v_mfma_f32_32x32x16_bf16 v[224:239], a[224:227], a[232:235], 0
s_waitcnt lgkmcnt(8)
ds_read_b128 a[104:107], v28 offset:1024
ds_read_b128 a[108:111], v28 offset:2048
v_exp_f32 v198, v198
v_exp_f32 v199, v199
v_add_f32 v42, v42, v196
v_add_f32 v42, v42, v197
v_mfma_f32_32x32x16_bf16 v[240:255], a[224:227], a[236:239], 0
s_waitcnt lgkmcnt(7)
ds_read_b64_tr_b16 a[112:113], v32 offset:36864
ds_read_b64_tr_b16 a[114:115], v32 offset:38912
ds_read_b128 a[116:119], v28 offset:3072
v_cvt_pk_bf16_f32 v194, v196, v197
v_add_f32 v42, v42, v198
v_add_f32 v42, v42, v199
v_cvt_pk_bf16_f32 v195, v198, v199
v_mfma_f32_32x32x16_bf16 v[208:223], a[240:243], a[244:247], v[208:223]
s_waitcnt lgkmcnt(9)
ds_read_b128 a[120:123], v28 offset:4096
ds_read_b128 a[124:127], v28 offset:5120
v_exp_f32 v200, v200
v_exp_f32 v201, v201
v_exp_f32 v202, v202
v_mfma_f32_32x32x16_bf16 v[224:239], a[240:243], a[248:251], v[224:239]
s_waitcnt lgkmcnt(10)
ds_read_b64_tr_b16 a[128:129], v33 offset:32768
ds_read_b64_tr_b16 a[130:131], v33 offset:34816
ds_read_b128 a[132:135], v29 offset:0
v_exp_f32 v203, v203
v_add_f32 v42, v42, v200
v_add_f32 v42, v42, v201
v_mfma_f32_32x32x16_bf16 v[240:255], a[240:243], a[252:255], v[240:255]
s_waitcnt lgkmcnt(10)
ds_read_b128 a[136:139], v29 offset:1024
ds_read_b128 a[140:143], v29 offset:2048
v_cvt_pk_bf16_f32 v196, v200, v201
v_exp_f32 v204, v204
v_exp_f32 v205, v205
v_add_f32 v42, v42, v202
v_mfma_f32_32x32x16_bf16 v[208:223], a[96:99], a[100:103], v[208:223]
s_waitcnt lgkmcnt(11)
ds_read_b64_tr_b16 a[144:145], v33 offset:36864
ds_read_b64_tr_b16 a[146:147], v33 offset:38912
ds_read_b128 a[148:151], v29 offset:3072
v_add_f32 v42, v42, v203
v_cvt_pk_bf16_f32 v197, v202, v203
v_exp_f32 v206, v206
v_mfma_f32_32x32x16_bf16 v[224:239], a[96:99], a[104:107], v[224:239]
s_waitcnt lgkmcnt(13)
ds_read_b128 a[152:155], v29 offset:4096
ds_read_b128 a[156:159], v29 offset:5120
v_exp_f32 v207, v207
v_add_f32 v42, v42, v204
v_add_f32 v42, v42, v205
v_cvt_pk_bf16_f32 v198, v204, v205
v_add_f32 v42, v42, v206
v_mfma_f32_32x32x16_bf16 v[240:255], a[96:99], a[108:111], v[240:255]
s_waitcnt lgkmcnt(12)
ds_read_b64_tr_b16 a[160:161], v34 offset:32768
ds_read_b64_tr_b16 a[162:163], v34 offset:34816
ds_read_b128 a[164:167], v30 offset:0
v_add_f32 v42, v42, v207
v_cvt_pk_bf16_f32 v199, v206, v207
v_exp_f32 v64, v64
v_mfma_f32_32x32x16_bf16 v[208:223], a[112:115], a[116:119], v[208:223]
s_waitcnt lgkmcnt(14)
ds_read_b128 a[168:171], v30 offset:1024
ds_read_b128 a[172:175], v30 offset:2048
v_exp_f32 v65, v65
v_exp_f32 v66, v66
v_exp_f32 v67, v67
v_mfma_f32_32x32x16_bf16 v[224:239], a[112:115], a[120:123], v[224:239]
s_waitcnt lgkmcnt(15)
ds_read_b64_tr_b16 a[176:177], v34 offset:36864
ds_read_b64_tr_b16 a[178:179], v34 offset:38912
ds_read_b128 a[180:183], v30 offset:3072
v_add_f32 v40, v40, v64
v_add_f32 v40, v40, v65
v_cvt_pk_bf16_f32 v64, v64, v65
v_mfma_f32_32x32x16_bf16 v[240:255], a[112:115], a[124:127], v[240:255]
s_waitcnt lgkmcnt(15)
ds_read_b128 a[184:187], v30 offset:4096
ds_read_b128 a[188:191], v30 offset:5120
v_exp_f32 v68, v68
v_exp_f32 v69, v69
v_add_f32 v40, v40, v66
v_add_f32 v40, v40, v67
v_cvt_pk_bf16_f32 v65, v66, v67
v_mfma_f32_32x32x16_bf16 v[208:223], a[128:131], a[132:135], v[208:223]
s_waitcnt lgkmcnt(15)
v_exp_f32 v70, v70
v_exp_f32 v71, v71
v_add_f32 v40, v40, v68
v_add_f32 v40, v40, v69
v_cvt_pk_bf16_f32 v66, v68, v69
v_mfma_f32_32x32x16_bf16 v[224:239], a[128:131], a[136:139], v[224:239]
v_add_f32 v40, v40, v70
v_add_f32 v40, v40, v71
v_cvt_pk_bf16_f32 v67, v70, v71
v_exp_f32 v72, v72
v_exp_f32 v73, v73
v_mfma_f32_32x32x16_bf16 v[240:255], a[128:131], a[140:143], v[240:255]
s_waitcnt lgkmcnt(12)
v_exp_f32 v74, v74
v_exp_f32 v75, v75
v_add_f32 v40, v40, v72
v_add_f32 v40, v40, v73
v_cvt_pk_bf16_f32 v68, v72, v73
v_mfma_f32_32x32x16_bf16 v[208:223], a[144:147], a[148:151], v[208:223]
s_waitcnt lgkmcnt(11)
v_exp_f32 v76, v76
v_exp_f32 v77, v77
v_add_f32 v40, v40, v74
v_add_f32 v40, v40, v75
v_cvt_pk_bf16_f32 v69, v74, v75
v_exp_f32 v78, v78
v_mfma_f32_32x32x16_bf16 v[224:239], a[144:147], a[152:155], v[224:239]
s_waitcnt lgkmcnt(10)
v_exp_f32 v79, v79
v_add_f32 v40, v40, v76
v_add_f32 v40, v40, v77
v_cvt_pk_bf16_f32 v70, v76, v77
v_add_f32 v40, v40, v78
v_add_f32 v40, v40, v79
v_mfma_f32_32x32x16_bf16 v[240:255], a[144:147], a[156:159], v[240:255]
s_waitcnt lgkmcnt(7)
v_cvt_pk_bf16_f32 v71, v78, v79
v_exp_f32 v80, v80
v_exp_f32 v81, v81
v_exp_f32 v82, v82
v_mfma_f32_32x32x16_bf16 v[208:223], a[160:163], a[164:167], v[208:223]
s_waitcnt lgkmcnt(6)
v_exp_f32 v83, v83
v_add_f32 v41, v41, v80
v_add_f32 v41, v41, v81
v_cvt_pk_bf16_f32 v80, v80, v81
v_exp_f32 v84, v84
v_mfma_f32_32x32x16_bf16 v[224:239], a[160:163], a[168:171], v[224:239]
s_waitcnt lgkmcnt(5)
s_waitcnt vmcnt(8) lgkmcnt(0)
s_barrier
v_mfma_f32_32x32x16_bf16 v[240:255], a[160:163], a[172:175], v[240:255]
ds_read_b64_tr_b16 a[224:225], v31 offset:0
ds_read_b64_tr_b16 a[226:227], v31 offset:2048
ds_read_b64_tr_b16 a[240:241], v31 offset:4096
s_add_u32 m0, s54, 32768
s_nop 0
buffer_load_dwordx4 v13, s[24:27], s49 offen offset:0 lds
v_mfma_f32_32x32x16_bf16 v[208:223], a[176:179], a[180:183], v[208:223]
ds_read_b64_tr_b16 a[242:243], v31 offset:6144
ds_read_b64_tr_b16 a[96:97], v32 offset:0
ds_read_b64_tr_b16 a[98:99], v32 offset:2048
v_exp_f32 v85, v85
v_add_f32 v41, v41, v82
v_add_f32 v41, v41, v83
v_cvt_pk_bf16_f32 v81, v82, v83
v_mfma_f32_32x32x16_bf16 v[224:239], a[176:179], a[184:187], v[224:239]
ds_read_b128 a[100:103], v28 offset:32768
ds_read_b128 a[104:107], v28 offset:33792
v_exp_f32 v86, v86
v_exp_f32 v87, v87
v_add_f32 v41, v41, v84
v_add_f32 v41, v41, v85
v_mfma_f32_32x32x16_bf16 v[240:255], a[176:179], a[188:191], v[240:255]
s_waitcnt lgkmcnt(6)
ds_read_b128 a[108:111], v28 offset:34816
ds_read_b64_tr_b16 a[112:113], v32 offset:4096
ds_read_b64_tr_b16 a[114:115], v32 offset:6144
buffer_load_dwordx4 v13, s[24:27], s49 offen offset:1024 lds
v_cvt_pk_bf16_f32 v82, v84, v85
v_add_f32 v41, v41, v86
v_add_f32 v41, v41, v87
v_mfma_f32_32x32x16_bf16 v[208:223], a[224:227], v[112:115], v[208:223]
ds_read_b128 a[116:119], v28 offset:35840
ds_read_b128 a[120:123], v28 offset:36864
v_cvt_pk_bf16_f32 v83, v86, v87
v_exp_f32 v88, v88
v_exp_f32 v89, v89
v_mfma_f32_32x32x16_bf16 v[224:239], a[224:227], v[128:131], v[224:239]
ds_read_b128 a[124:127], v28 offset:37888
ds_read_b64_tr_b16 a[128:129], v33 offset:0
ds_read_b64_tr_b16 a[130:131], v33 offset:2048
v_exp_f32 v90, v90
v_exp_f32 v91, v91
v_add_f32 v41, v41, v88
v_mfma_f32_32x32x16_bf16 v[240:255], a[224:227], v[144:147], v[240:255]
s_waitcnt lgkmcnt(12)
ds_read_b128 a[132:135], v29 offset:32768
ds_read_b128 a[136:139], v29 offset:33792
buffer_load_dwordx4 v13, s[24:27], s49 offen offset:2048 lds
v_add_f32 v41, v41, v89
v_cvt_pk_bf16_f32 v84, v88, v89
v_mfma_f32_32x32x16_bf16 v[208:223], a[240:243], v[116:119], v[208:223]
ds_read_b128 a[140:143], v29 offset:34816
ds_read_b64_tr_b16 a[144:145], v33 offset:4096
ds_read_b64_tr_b16 a[146:147], v33 offset:6144
v_exp_f32 v92, v92
v_exp_f32 v93, v93
v_add_f32 v41, v41, v90
v_add_f32 v41, v41, v91
v_mfma_f32_32x32x16_bf16 v[224:239], a[240:243], v[132:135], v[224:239]
ds_read_b128 a[148:151], v29 offset:35840
ds_read_b128 a[152:155], v29 offset:36864
v_cvt_pk_bf16_f32 v85, v90, v91
v_exp_f32 v94, v94
v_exp_f32 v95, v95
v_mfma_f32_32x32x16_bf16 v[240:255], a[240:243], v[148:151], v[240:255]
s_waitcnt lgkmcnt(15)
ds_read_b128 a[156:159], v29 offset:37888
ds_read_b64_tr_b16 a[160:161], v34 offset:0
ds_read_b64_tr_b16 a[162:163], v34 offset:2048
buffer_load_dwordx4 v13, s[24:27], s49 offen offset:3072 lds
v_add_f32 v41, v41, v92
v_add_f32 v41, v41, v93
v_cvt_pk_bf16_f32 v86, v92, v93
v_mfma_f32_32x32x16_bf16 v[208:223], a[96:99], a[100:103], v[208:223]
ds_read_b128 a[164:167], v30 offset:32768
ds_read_b128 a[168:171], v30 offset:33792
v_add_f32 v41, v41, v94
v_add_f32 v41, v41, v95
v_cvt_pk_bf16_f32 v87, v94, v95
v_exp_f32 v96, v96
v_mfma_f32_32x32x16_bf16 v[224:239], a[96:99], a[104:107], v[224:239]
s_waitcnt lgkmcnt(15)
s_add_u32 m0, s54, 36864
ds_read_b128 a[172:175], v30 offset:34816
ds_read_b64_tr_b16 a[176:177], v34 offset:4096
ds_read_b64_tr_b16 a[178:179], v34 offset:6144
v_exp_f32 v97, v97
v_exp_f32 v98, v98
v_mfma_f32_32x32x16_bf16 v[240:255], a[96:99], a[108:111], v[240:255]
ds_read_b128 a[180:183], v30 offset:35840
ds_read_b128 a[184:187], v30 offset:36864
buffer_load_dwordx4 v13, s[24:27], s50 offen offset:0 lds
v_exp_f32 v99, v99
v_add_f32 v42, v42, v96
v_mfma_f32_32x32x16_bf16 v[208:223], a[112:115], a[116:119], v[208:223]
ds_read_b128 a[188:191], v30 offset:37888
v_add_f32 v42, v42, v97
v_cvt_pk_bf16_f32 v96, v96, v97
v_exp_f32 v100, v100
v_exp_f32 v101, v101
v_add_f32 v42, v42, v98
v_mfma_f32_32x32x16_bf16 v[224:239], a[112:115], a[120:123], v[224:239]
s_waitcnt lgkmcnt(15)
ds_write_b128 v27, v[160:163] offset:0
v_add_u32 v31, 0x8000, v31
v_add_u32 v32, 0x8000, v32
v_mfma_f32_32x32x16_bf16 v[240:255], a[112:115], a[124:127], v[240:255]
buffer_load_dwordx4 v13, s[24:27], s50 offen offset:1024 lds
v_add_u32 v33, 0x8000, v33
v_add_u32 v34, 0x8000, v34
v_add_f32 v42, v42, v99
v_cvt_pk_bf16_f32 v97, v98, v99
v_mfma_f32_32x32x16_bf16 v[208:223], a[128:131], a[132:135], v[208:223]
ds_write_b128 v27, v[164:167] offset:3072
v_exp_f32 v102, v102
v_exp_f32 v103, v103
v_mfma_f32_32x32x16_bf16 v[224:239], a[128:131], a[136:139], v[224:239]
v_add_f32 v42, v42, v100
v_add_f32 v42, v42, v101
v_cvt_pk_bf16_f32 v98, v100, v101
v_add_f32 v42, v42, v102
v_add_f32 v42, v42, v103
v_cvt_pk_bf16_f32 v99, v102, v103
v_mfma_f32_32x32x16_bf16 v[240:255], a[128:131], a[140:143], v[240:255]
s_waitcnt lgkmcnt(14)
buffer_load_dwordx4 v13, s[24:27], s50 offen offset:2048 lds
v_exp_f32 v104, v104
v_exp_f32 v105, v105
v_exp_f32 v106, v106
v_mfma_f32_32x32x16_bf16 v[208:223], a[144:147], a[148:151], v[208:223]
s_waitcnt lgkmcnt(13)
ds_write_b128 v27, v[176:179] offset:1024
v_exp_f32 v107, v107
v_add_f32 v42, v42, v104
v_mfma_f32_32x32x16_bf16 v[224:239], a[144:147], a[152:155], v[224:239]
s_waitcnt lgkmcnt(13)
ds_write_b128 v27, v[180:183] offset:4096
v_add_f32 v42, v42, v105
v_cvt_pk_bf16_f32 v100, v104, v105
v_mfma_f32_32x32x16_bf16 v[240:255], a[144:147], a[156:159], v[240:255]
s_waitcnt lgkmcnt(11)
buffer_load_dwordx4 v13, s[24:27], s50 offen offset:3072 lds
ds_write_b128 v27, v[192:195] offset:2048
ds_write_b128 v27, v[196:199] offset:5120
v_mfma_f32_32x32x16_bf16 v[208:223], a[160:163], a[164:167], v[208:223]
s_waitcnt lgkmcnt(12)
v_exp_f32 v108, v108
v_exp_f32 v109, v109
v_add_f32 v42, v42, v106
v_add_f32 v42, v42, v107
v_cvt_pk_bf16_f32 v101, v106, v107
v_mfma_f32_32x32x16_bf16 v[224:239], a[160:163], a[168:171], v[224:239]
s_waitcnt lgkmcnt(11)
s_waitcnt vmcnt(8) lgkmcnt(0)
s_barrier
v_mfma_f32_32x32x16_bf16 v[240:255], a[160:163], a[172:175], v[240:255]
ds_read_b64_tr_b16 a[224:225], v31 offset:32768
ds_read_b64_tr_b16 a[226:227], v31 offset:34816
ds_read_b64_tr_b16 a[240:241], v31 offset:36864
s_add_u32 m0, s54, 0
s_nop 0
buffer_load_dwordx4 v1, s[96:99], s83 offen offset:0 lds
v_mfma_f32_32x32x16_bf16 v[208:223], a[176:179], a[180:183], v[208:223]
ds_read_b64_tr_b16 a[242:243], v31 offset:38912
ds_read_b64_tr_b16 a[96:97], v32 offset:32768
ds_read_b64_tr_b16 a[98:99], v32 offset:34816
v_exp_f32 v110, v110
v_exp_f32 v111, v111
v_add_f32 v42, v42, v108
v_add_f32 v42, v42, v109
v_mfma_f32_32x32x16_bf16 v[224:239], a[176:179], a[184:187], v[224:239]
ds_read_b128 a[100:103], v28 offset:0
ds_read_b128 a[104:107], v28 offset:1024
v_cvt_pk_bf16_f32 v102, v108, v109
v_add_f32 v42, v42, v110
v_add_f32 v42, v42, v111
v_cvt_pk_bf16_f32 v103, v110, v111
v_mov_b32 v48, v40
v_mfma_f32_32x32x16_bf16 v[240:255], a[176:179], a[188:191], v[240:255]
s_waitcnt lgkmcnt(6)
ds_read_b128 a[108:111], v28 offset:2048
ds_read_b64_tr_b16 a[112:113], v32 offset:36864
ds_read_b64_tr_b16 a[114:115], v32 offset:38912
buffer_load_dwordx4 v2, s[96:99], s83 offen offset:1024 lds
v_mov_b32 v49, v41
v_mov_b32 v50, v42
v_permlane32_swap_b32 v48, v40
v_mfma_f32_32x32x16_bf16 v[208:223], a[224:227], v[160:163], v[208:223]
ds_read_b128 a[116:119], v28 offset:3072
ds_read_b128 a[120:123], v28 offset:4096
v_permlane32_swap_b32 v49, v41
v_permlane32_swap_b32 v50, v42
v_add_f32 v40, v40, v48
v_add_f32 v41, v41, v49
v_add_f32 v42, v42, v50
v_mfma_f32_32x32x16_bf16 v[224:239], a[224:227], v[176:179], v[224:239]
s_add_u32 s57, s83, 36864
ds_read_b128 a[124:127], v28 offset:5120
ds_read_b64_tr_b16 a[128:129], v33 offset:32768
ds_read_b64_tr_b16 a[130:131], v33 offset:34816
v_mfma_f32_32x32x16_bf16 v[240:255], a[224:227], v[192:195], v[240:255]
s_waitcnt lgkmcnt(12)
ds_read_b128 a[132:135], v29 offset:0
ds_read_b128 a[136:139], v29 offset:1024
buffer_load_dwordx4 v3, s[96:99], s83 offen offset:2048 lds
v_mfma_f32_32x32x16_bf16 v[208:223], a[240:243], v[164:167], v[208:223]
ds_read_b128 a[140:143], v29 offset:2048
ds_read_b64_tr_b16 a[144:145], v33 offset:36864
ds_read_b64_tr_b16 a[146:147], v33 offset:38912
v_mfma_f32_32x32x16_bf16 v[224:239], a[240:243], v[180:183], v[224:239]
ds_read_b128 a[148:151], v29 offset:3072
ds_read_b128 a[152:155], v29 offset:4096
v_mfma_f32_32x32x16_bf16 v[240:255], a[240:243], v[196:199], v[240:255]
s_waitcnt lgkmcnt(15)
ds_read_b128 a[156:159], v29 offset:5120
ds_read_b64_tr_b16 a[160:161], v34 offset:32768
ds_read_b64_tr_b16 a[162:163], v34 offset:34816
buffer_load_dwordx4 v4, s[96:99], s83 offen offset:3072 lds
v_mfma_f32_32x32x16_bf16 v[208:223], a[96:99], a[100:103], v[208:223]
ds_read_b128 a[164:167], v30 offset:0
ds_read_b128 a[168:171], v30 offset:1024
v_mfma_f32_32x32x16_bf16 v[224:239], a[96:99], a[104:107], v[224:239]
s_waitcnt lgkmcnt(15)
s_add_u32 m0, s54, 4096
ds_read_b128 a[172:175], v30 offset:2048
ds_read_b64_tr_b16 a[176:177], v34 offset:36864
ds_read_b64_tr_b16 a[178:179], v34 offset:38912
v_mfma_f32_32x32x16_bf16 v[240:255], a[96:99], a[108:111], v[240:255]
ds_read_b128 a[180:183], v30 offset:3072
ds_read_b128 a[184:187], v30 offset:4096
buffer_load_dwordx4 v1, s[96:99], s57 offen offset:0 lds
v_mfma_f32_32x32x16_bf16 v[208:223], a[112:115], a[116:119], v[208:223]
ds_read_b128 a[188:191], v30 offset:5120
v_mfma_f32_32x32x16_bf16 v[224:239], a[112:115], a[120:123], v[224:239]
s_waitcnt lgkmcnt(15)
ds_write_b128 v27, v[64:67] offset:32768
v_mfma_f32_32x32x16_bf16 v[240:255], a[112:115], a[124:127], v[240:255]
buffer_load_dwordx4 v2, s[96:99], s57 offen offset:1024 lds
v_mfma_f32_32x32x16_bf16 v[208:223], a[128:131], a[132:135], v[208:223]
ds_write_b128 v27, v[68:71] offset:35840
v_mfma_f32_32x32x16_bf16 v[224:239], a[128:131], a[136:139], v[224:239]
ds_write_b128 v27, v[80:83] offset:33792
v_mfma_f32_32x32x16_bf16 v[240:255], a[128:131], a[140:143], v[240:255]
s_waitcnt lgkmcnt(15)
buffer_load_dwordx4 v3, s[96:99], s57 offen offset:2048 lds
v_mfma_f32_32x32x16_bf16 v[208:223], a[144:147], a[148:151], v[208:223]
s_waitcnt lgkmcnt(14)
ds_write_b128 v27, v[84:87] offset:36864
v_mfma_f32_32x32x16_bf16 v[224:239], a[144:147], a[152:155], v[224:239]
s_waitcnt lgkmcnt(14)
ds_write_b128 v27, v[96:99] offset:34816
v_mfma_f32_32x32x16_bf16 v[240:255], a[144:147], a[156:159], v[240:255]
s_waitcnt lgkmcnt(12)
buffer_load_dwordx4 v4, s[96:99], s57 offen offset:3072 lds
ds_write_b128 v27, v[100:103] offset:37888
ds_write_b128 v27, v[40:43] offset:38912
v_mfma_f32_32x32x16_bf16 v[208:223], a[160:163], a[164:167], v[208:223]
s_waitcnt lgkmcnt(13)
v_mfma_f32_32x32x16_bf16 v[224:239], a[160:163], a[168:171], v[224:239]
s_waitcnt lgkmcnt(12)
s_waitcnt vmcnt(8) lgkmcnt(0)
s_barrier
v_mfma_f32_32x32x16_bf16 v[240:255], a[160:163], a[172:175], v[240:255]
ds_read_b64_tr_b16 a[224:225], v31 offset:0
ds_read_b64_tr_b16 a[226:227], v31 offset:2048
ds_read_b64_tr_b16 a[240:241], v31 offset:4096
s_add_u32 m0, s54, 65536
s_nop 0
buffer_load_dwordx4 v1, s[96:99], s84 offen offset:0 lds
v_mfma_f32_32x32x16_bf16 v[208:223], a[176:179], a[180:183], v[208:223]
ds_read_b64_tr_b16 a[242:243], v31 offset:6144
ds_read_b64_tr_b16 a[96:97], v32 offset:0
ds_read_b64_tr_b16 a[98:99], v32 offset:2048
v_mfma_f32_32x32x16_bf16 v[224:239], a[176:179], a[184:187], v[224:239]
ds_read_b128 a[100:103], v28 offset:32768
ds_read_b128 a[104:107], v28 offset:33792
buffer_load_dwordx4 v2, s[96:99], s84 offen offset:1024 lds
v_mfma_f32_32x32x16_bf16 v[240:255], a[176:179], a[188:191], v[240:255]
s_waitcnt lgkmcnt(6)
s_add_u32 s57, s84, 36864
ds_read_b128 a[108:111], v28 offset:34816
ds_read_b64_tr_b16 a[112:113], v32 offset:4096
ds_read_b64_tr_b16 a[114:115], v32 offset:6144
v_mfma_f32_32x32x16_bf16 v[208:223], a[224:227], v[64:67], v[208:223]
ds_read_b128 a[116:119], v28 offset:35840
ds_read_b128 v[48:51], v26 offset:38912
buffer_load_dwordx4 v3, s[96:99], s84 offen offset:2048 lds
v_mfma_f32_32x32x16_bf16 v[224:239], a[224:227], v[80:83], v[224:239]
ds_read_b128 v[52:55], v26 offset:47104
ds_read_b128 v[56:59], v26 offset:55296
v_mfma_f32_32x32x16_bf16 v[240:255], a[224:227], v[96:99], v[240:255]
s_waitcnt lgkmcnt(11)
ds_read_b128 v[60:63], v26 offset:63488
ds_read_b64_tr_b16 a[128:129], v33 offset:0
ds_read_b64_tr_b16 a[130:131], v33 offset:2048
buffer_load_dwordx4 v4, s[96:99], s84 offen offset:3072 lds
v_mfma_f32_32x32x16_bf16 v[208:223], a[240:243], v[68:71], v[208:223]
s_add_u32 m0, s54, 69632
ds_read_b128 a[132:135], v29 offset:32768
ds_read_b64_tr_b16 a[144:145], v33 offset:4096
ds_read_b64_tr_b16 a[146:147], v33 offset:6144
v_mfma_f32_32x32x16_bf16 v[224:239], a[240:243], v[84:87], v[224:239]
ds_read_b128 a[148:151], v29 offset:35840
ds_read_b64_tr_b16 a[160:161], v34 offset:0
ds_read_b64_tr_b16 a[162:163], v34 offset:2048
buffer_load_dwordx4 v1, s[96:99], s57 offen offset:0 lds
v_mfma_f32_32x32x16_bf16 v[240:255], a[240:243], v[100:103], v[240:255]
s_waitcnt lgkmcnt(15)
ds_read_b128 a[164:167], v30 offset:32768
ds_read_b64_tr_b16 a[176:177], v34 offset:4096
ds_read_b64_tr_b16 a[178:179], v34 offset:6144
v_mfma_f32_32x32x16_bf16 v[208:223], a[96:99], a[100:103], v[208:223]
ds_read_b128 a[180:183], v30 offset:35840
ds_read_b128 a[120:123], v28 offset:36864
buffer_load_dwordx4 v2, s[96:99], s57 offen offset:1024 lds
v_mfma_f32_32x32x16_bf16 v[224:239], a[96:99], a[104:107], v[224:239]
ds_read_b128 a[136:139], v29 offset:33792
ds_read_b128 a[152:155], v29 offset:36864
v_mfma_f32_32x32x16_bf16 v[240:255], a[96:99], a[108:111], v[240:255]
s_waitcnt lgkmcnt(15)
ds_read_b128 a[168:171], v30 offset:33792
ds_read_b128 a[184:187], v30 offset:36864
buffer_load_dwordx4 v3, s[96:99], s57 offen offset:2048 lds
v_mfma_f32_32x32x16_bf16 v[208:223], a[112:115], a[116:119], v[208:223]
s_waitcnt lgkmcnt(14)
ds_read_b128 a[124:127], v28 offset:37888
ds_read_b128 a[140:143], v29 offset:34816
v_add_f32 v40, v48, v52
v_add_f32 v41, v49, v53
v_add_f32 v42, v50, v54
v_add_f32 v48, v56, v60
v_add_f32 v49, v57, v61
v_mfma_f32_32x32x16_bf16 v[208:223], a[128:131], a[132:135], v[208:223]
s_waitcnt lgkmcnt(13)
ds_read_b128 a[156:159], v29 offset:37888
ds_read_b128 a[172:175], v30 offset:34816
buffer_load_dwordx4 v4, s[96:99], s57 offen offset:3072 lds
v_add_f32 v50, v58, v62
v_add_f32 v40, v40, v48
v_add_f32 v41, v41, v49
v_add_f32 v42, v42, v50
v_mfma_f32_32x32x16_bf16 v[208:223], a[144:147], a[148:151], v[208:223]
s_waitcnt lgkmcnt(12)
s_add_u32 m0, s54, 98304
ds_read_b128 a[188:191], v30 offset:37888
v_mov_b32 v54, 0x35800000
v_mov_b32 v55, 0x4e800000
v_min3_f32 v52, v40, v41, v42
v_add_f32 v53, v40, v41
v_add_f32 v53, v53, v42
v_mfma_f32_32x32x16_bf16 v[208:223], a[160:163], a[164:167], v[208:223]
s_waitcnt lgkmcnt(10)
buffer_load_dwordx4 v1, s[96:99], s85 offen offset:0 lds
v_cmp_gt_f32 vcc, v52, v54
v_cmp_lt_f32 s[92:93], v53, v55
v_rcp_f32 v40, v40
v_rcp_f32 v41, v41
v_mfma_f32_32x32x16_bf16 v[208:223], a[176:179], a[180:183], v[208:223]
s_waitcnt lgkmcnt(9)
v_rcp_f32 v42, v42
v_mfma_f32_32x32x16_bf16 v[224:239], a[112:115], a[120:123], v[224:239]
s_waitcnt lgkmcnt(8)
s_waitcnt vmcnt(9) lgkmcnt(0)
s_barrier
v_mfma_f32_32x32x16_bf16 v[224:239], a[128:131], a[136:139], v[224:239]
ds_read_b64_tr_b16 v[64:65], v5 offset:0
ds_read_b64_tr_b16 v[66:67], v5 offset:1024
ds_read_b64_tr_b16 v[68:69], v5 offset:4096
buffer_load_dwordx4 v2, s[96:99], s85 offen offset:1024 lds
s_nop 0
v_mul_f32 v208, v208, v40
v_mul_f32 v209, v209, v40
v_mfma_f32_32x32x16_bf16 v[224:239], a[144:147], a[152:155], v[224:239]
s_add_u32 s57, s85, 36864
ds_read_b64_tr_b16 v[70:71], v5 offset:5120
ds_read_b64_tr_b16 v[72:73], v5 offset:8192
ds_read_b64_tr_b16 v[74:75], v5 offset:9216
v_mul_f32 v210, v210, v40
v_mul_f32 v211, v211, v40
v_mul_f32 v212, v212, v40
v_mul_f32 v213, v213, v40
v_mfma_f32_32x32x16_bf16 v[224:239], a[160:163], a[168:171], v[224:239]
ds_read_b64_tr_b16 v[76:77], v5 offset:12288
ds_read_b64_tr_b16 v[78:79], v5 offset:13312
ds_read_b64_tr_b16 v[80:81], v5 offset:16384
buffer_load_dwordx4 v3, s[96:99], s85 offen offset:2048 lds
v_mul_f32 v214, v214, v40
v_mul_f32 v215, v215, v40
v_mfma_f32_32x32x16_bf16 v[224:239], a[176:179], a[184:187], v[224:239]
ds_read_b64_tr_b16 v[82:83], v5 offset:17408
ds_read_b64_tr_b16 v[84:85], v5 offset:20480
ds_read_b64_tr_b16 v[86:87], v5 offset:21504
v_cvt_pk_bf16_f32 v208, v208, v209
v_cvt_pk_bf16_f32 v209, v210, v211
v_cvt_pk_bf16_f32 v210, v212, v213
v_cvt_pk_bf16_f32 v211, v214, v215
v_mul_f32 v216, v216, v40
v_mfma_f32_32x32x16_bf16 v[240:255], a[112:115], a[124:127], v[240:255]
ds_read_b64_tr_b16 v[88:89], v5 offset:24576
ds_read_b64_tr_b16 v[90:91], v5 offset:25600
ds_read_b64_tr_b16 v[92:93], v5 offset:28672
buffer_load_dwordx4 v4, s[96:99], s85 offen offset:3072 lds
v_mul_f32 v217, v217, v40
v_mul_f32 v218, v218, v40
v_mfma_f32_32x32x16_bf16 v[240:255], a[128:131], a[140:143], v[240:255]
s_add_u32 m0, s54, 102400
ds_read_b64_tr_b16 v[94:95], v5 offset:29696
v_mul_f32 v219, v219, v40
v_mul_f32 v220, v220, v40
v_mul_f32 v221, v221, v40
v_mul_f32 v222, v222, v40
v_mul_f32 v223, v223, v40
v_cvt_pk_bf16_f32 v212, v216, v217
v_mfma_f32_32x32x16_bf16 v[240:255], a[144:147], a[156:159], v[240:255]
buffer_load_dwordx4 v1, s[96:99], s57 offen offset:0 lds
v_cvt_pk_bf16_f32 v213, v218, v219
v_cvt_pk_bf16_f32 v214, v220, v221
v_cvt_pk_bf16_f32 v215, v222, v223
v_mul_f32 v224, v224, v41
v_mul_f32 v225, v225, v41
v_mfma_f32_32x32x16_bf16 v[240:255], a[160:163], a[172:175], v[240:255]
ds_write_b128 v8, v[208:211] offset:0
v_mul_f32 v226, v226, v41
v_mul_f32 v227, v227, v41
v_mfma_f32_32x32x16_bf16 v[240:255], a[176:179], a[188:191], v[240:255]
buffer_load_dwordx4 v2, s[96:99], s57 offen offset:1024 lds
v_mul_f32 v228, v228, v41
v_mul_f32 v229, v229, v41
v_mul_f32 v230, v230, v41
v_mul_f32 v231, v231, v41
v_cvt_pk_bf16_f32 v224, v224, v225
v_cvt_pk_bf16_f32 v225, v226, v227
ds_write_b128 v8, v[212:215] offset:512
v_cvt_pk_bf16_f32 v226, v228, v229
v_cvt_pk_bf16_f32 v227, v230, v231
ds_write_b128 v8, v[224:227] offset:2048
v_mul_f32 v232, v232, v41
v_mul_f32 v233, v233, v41
v_mul_f32 v234, v234, v41
v_mul_f32 v235, v235, v41
v_mul_f32 v236, v236, v41
v_mul_f32 v237, v237, v41
v_mul_f32 v238, v238, v41
v_mul_f32 v239, v239, v41
v_cvt_pk_bf16_f32 v228, v232, v233
v_cvt_pk_bf16_f32 v229, v234, v235
v_cvt_pk_bf16_f32 v230, v236, v237
v_cvt_pk_bf16_f32 v231, v238, v239
ds_write_b128 v8, v[228:231] offset:2560
v_pk_mul_f32 v[240:241], v[240:241], v[42:43] op_sel:[0,0] op_sel_hi:[1,0]
v_pk_mul_f32 v[242:243], v[242:243], v[42:43] op_sel:[0,0] op_sel_hi:[1,0]
v_pk_mul_f32 v[244:245], v[244:245], v[42:43] op_sel:[0,0] op_sel_hi:[1,0]
v_pk_mul_f32 v[246:247], v[246:247], v[42:43] op_sel:[0,0] op_sel_hi:[1,0]
v_cvt_pk_bf16_f32 v240, v240, v241
v_cvt_pk_bf16_f32 v241, v242, v243
v_cvt_pk_bf16_f32 v242, v244, v245
v_cvt_pk_bf16_f32 v243, v246, v247
ds_write_b128 v8, v[240:243] offset:4096
buffer_load_dwordx4 v3, s[96:99], s57 offen offset:2048 lds
buffer_load_dwordx4 v4, s[96:99], s57 offen offset:3072 lds
v_pk_mul_f32 v[248:249], v[248:249], v[42:43] op_sel:[0,0] op_sel_hi:[1,0]
v_pk_mul_f32 v[250:251], v[250:251], v[42:43] op_sel:[0,0] op_sel_hi:[1,0]
v_pk_mul_f32 v[252:253], v[252:253], v[42:43] op_sel:[0,0] op_sel_hi:[1,0]
v_pk_mul_f32 v[254:255], v[254:255], v[42:43] op_sel:[0,0] op_sel_hi:[1,0]
v_cvt_pk_bf16_f32 v244, v248, v249
v_cvt_pk_bf16_f32 v245, v250, v251
v_cvt_pk_bf16_f32 v246, v252, v253
v_cvt_pk_bf16_f32 v247, v254, v255
ds_write_b128 v8, v[244:247] offset:4608
s_add_u32 m0, s54, 32768
s_nop 0
buffer_load_dwordx4 v1, s[96:99], s86 offen offset:0 lds
buffer_load_dwordx4 v2, s[96:99], s86 offen offset:1024 lds
s_add_u32 s57, s86, 36864
buffer_load_dwordx4 v3, s[96:99], s86 offen offset:2048 lds
buffer_load_dwordx4 v4, s[96:99], s86 offen offset:3072 lds
s_add_u32 m0, s54, 36864
s_nop 0
buffer_load_dwordx4 v1, s[96:99], s57 offen offset:0 lds
buffer_load_dwordx4 v2, s[96:99], s57 offen offset:1024 lds
buffer_load_dwordx4 v3, s[96:99], s57 offen offset:2048 lds
buffer_load_dwordx4 v4, s[96:99], s57 offen offset:3072 lds
s_and_b64 vcc, vcc, s[92:93]
s_cmp_eq_u64 vcc, -1
s_cbranch_scc0 K1_SLOW
K1_EPI:
s_waitcnt vmcnt(16) lgkmcnt(0)
s_barrier
ds_read_b128 a[96:99], v26 offset:32768
ds_read_b128 a[100:103], v26 offset:33792
ds_read_b128 a[104:107], v26 offset:34816
ds_read_b128 a[108:111], v26 offset:40960
ds_read_b128 a[112:115], v26 offset:41984
ds_read_b128 a[116:119], v26 offset:43008
ds_read_b128 a[120:123], v26 offset:49152
ds_read_b128 a[124:127], v26 offset:50176
ds_read_b128 a[128:131], v26 offset:51200
s_waitcnt lgkmcnt(8)
v_mfma_f32_16x16x32_bf16 v[128:131], v[64:67], a[96:99], 0
s_waitcnt lgkmcnt(7)
s_add_u32 m0, s54, 0
ds_read_b128 a[132:135], v26 offset:57344
v_mfma_f32_16x16x32_bf16 v[132:135], v[64:67], a[100:103], 0
s_waitcnt lgkmcnt(7)
ds_read_b128 a[136:139], v26 offset:58368
buffer_load_dwordx4 v1, s[96:99], s87 offen offset:0 lds
v_mfma_f32_16x16x32_bf16 v[136:139], v[64:67], a[104:107], 0
s_waitcnt lgkmcnt(7)
ds_read_b128 a[140:143], v26 offset:59392
v_mfma_f32_16x16x32_bf16 v[128:131], v[68:71], a[108:111], v[128:131]
s_waitcnt lgkmcnt(7)
ds_read_b128 a[144:147], v26 offset:35840
v_and_b32 v9, 3, v0
v_mfma_f32_16x16x32_bf16 v[132:135], v[68:71], a[112:115], v[132:135]
s_waitcnt lgkmcnt(7)
ds_read_b128 a[148:151], v26 offset:36864
buffer_load_dwordx4 v2, s[96:99], s87 offen offset:1024 lds
v_mfma_f32_16x16x32_bf16 v[136:139], v[68:71], a[116:119], v[136:139]
s_waitcnt lgkmcnt(7)
ds_read_b128 a[152:155], v26 offset:37888
v_mfma_f32_16x16x32_bf16 v[128:131], v[72:75], a[120:123], v[128:131]
s_waitcnt lgkmcnt(7)
s_add_u32 s57, s87, 36864
ds_read_b128 a[156:159], v26 offset:44032
v_mfma_f32_16x16x32_bf16 v[132:135], v[72:75], a[124:127], v[132:135]
s_waitcnt lgkmcnt(7)
ds_read_b128 a[160:163], v26 offset:45056
buffer_load_dwordx4 v3, s[96:99], s87 offen offset:2048 lds
v_mfma_f32_16x16x32_bf16 v[136:139], v[72:75], a[128:131], v[136:139]
s_waitcnt lgkmcnt(7)
ds_read_b128 a[164:167], v26 offset:46080
v_mfma_f32_16x16x32_bf16 v[128:131], v[76:79], a[132:135], v[128:131]
s_waitcnt lgkmcnt(7)
ds_read_b128 a[168:171], v26 offset:52224
v_and_b32 v10, 12, v0
v_mfma_f32_16x16x32_bf16 v[132:135], v[76:79], a[136:139], v[132:135]
s_waitcnt lgkmcnt(7)
ds_read_b128 a[172:175], v26 offset:53248
buffer_load_dwordx4 v4, s[96:99], s87 offen offset:3072 lds
v_mfma_f32_16x16x32_bf16 v[136:139], v[76:79], a[140:143], v[136:139]
s_waitcnt lgkmcnt(7)
ds_read_b128 a[176:179], v26 offset:54272
v_mfma_f32_16x16x32_bf16 v[128:131], v[80:83], a[144:147], v[128:131]
s_waitcnt lgkmcnt(7)
s_add_u32 m0, s54, 4096
ds_read_b128 a[180:183], v26 offset:60416
v_mfma_f32_16x16x32_bf16 v[132:135], v[80:83], a[148:151], v[132:135]
s_waitcnt lgkmcnt(7)
ds_read_b128 a[184:187], v26 offset:61440
buffer_load_dwordx4 v1, s[96:99], s57 offen offset:0 lds
v_mfma_f32_16x16x32_bf16 v[136:139], v[80:83], a[152:155], v[136:139]
s_waitcnt lgkmcnt(7)
ds_read_b128 a[188:191], v26 offset:62464
v_mfma_f32_16x16x32_bf16 v[128:131], v[84:87], a[156:159], v[128:131]
s_waitcnt lgkmcnt(7)
ds_read_b64_tr_b16 v[96:97], v6 offset:0
v_lshlrev_b32 v9, 4, v9
v_mfma_f32_16x16x32_bf16 v[132:135], v[84:87], a[160:163], v[132:135]
s_waitcnt lgkmcnt(7)
ds_read_b64_tr_b16 v[98:99], v6 offset:1024
buffer_load_dwordx4 v2, s[96:99], s57 offen offset:1024 lds
v_mfma_f32_16x16x32_bf16 v[136:139], v[84:87], a[164:167], v[136:139]
s_waitcnt lgkmcnt(7)
ds_read_b64_tr_b16 v[100:101], v6 offset:4096
v_mfma_f32_16x16x32_bf16 v[128:131], v[88:91], a[168:171], v[128:131]
s_waitcnt lgkmcnt(7)
ds_read_b64_tr_b16 v[102:103], v6 offset:5120
v_lshl_add_u32 v9, v10, 6, v9
v_mfma_f32_16x16x32_bf16 v[132:135], v[88:91], a[172:175], v[132:135]
s_waitcnt lgkmcnt(7)
buffer_load_dwordx4 v3, s[96:99], s57 offen offset:2048 lds
v_mfma_f32_16x16x32_bf16 v[136:139], v[88:91], a[176:179], v[136:139]
s_waitcnt lgkmcnt(6)
ds_read_b64_tr_b16 v[104:105], v6 offset:8192
v_and_b32 v10, 48, v0
v_mfma_f32_16x16x32_bf16 v[128:131], v[92:95], a[180:183], v[128:131]
s_waitcnt lgkmcnt(6)
ds_read_b64_tr_b16 v[106:107], v6 offset:9216
v_lshl_add_u32 v9, v10, 2, v9
v_mfma_f32_16x16x32_bf16 v[132:135], v[92:95], a[184:187], v[132:135]
s_waitcnt lgkmcnt(6)
buffer_load_dwordx4 v4, s[96:99], s57 offen offset:3072 lds
v_mfma_f32_16x16x32_bf16 v[136:139], v[92:95], a[188:191], v[136:139]
s_waitcnt lgkmcnt(4)
ds_read_b64_tr_b16 v[108:109], v6 offset:12288
v_lshrrev_b32 v230, 1, v9
v_mfma_f32_16x16x32_bf16 v[140:143], v[96:99], a[96:99], 0
s_waitcnt vmcnt(16)
s_barrier
v_mfma_f32_16x16x32_bf16 v[144:147], v[96:99], a[100:103], 0
ds_read_b64_tr_b16 v[110:111], v6 offset:13312
s_add_u32 m0, s54, 131072
s_nop 0
buffer_load_dwordx4 v1, s[96:99], s88 offen offset:0 lds
v_mfma_f32_16x16x32_bf16 v[148:151], v[96:99], a[104:107], 0
s_waitcnt lgkmcnt(4)
ds_read_b64_tr_b16 v[112:113], v6 offset:16384
v_mfma_f32_16x16x32_bf16 v[140:143], v[100:103], a[108:111], v[140:143]
ds_read_b64_tr_b16 v[114:115], v6 offset:17408
v_mfma_f32_16x16x32_bf16 v[144:147], v[100:103], a[112:115], v[144:147]
buffer_load_dwordx4 v2, s[96:99], s88 offen offset:1024 lds
v_mfma_f32_16x16x32_bf16 v[148:151], v[100:103], a[116:119], v[148:151]
s_waitcnt lgkmcnt(4)
ds_read_b64_tr_b16 v[116:117], v6 offset:20480
v_bfe_u32 v10, v0, 2, 2
v_mfma_f32_16x16x32_bf16 v[140:143], v[104:107], a[120:123], v[140:143]
s_add_u32 s57, s88, 36864
ds_read_b64_tr_b16 v[118:119], v6 offset:21504
v_mfma_f32_16x16x32_bf16 v[144:147], v[104:107], a[124:127], v[144:147]
buffer_load_dwordx4 v3, s[96:99], s88 offen offset:2048 lds
v_mfma_f32_16x16x32_bf16 v[148:151], v[104:107], a[128:131], v[148:151]
s_waitcnt lgkmcnt(4)
ds_read_b64_tr_b16 v[120:121], v6 offset:24576
v_sub_u32 v10, s1, v10
v_mfma_f32_16x16x32_bf16 v[140:143], v[108:111], a[132:135], v[140:143]
ds_read_b64_tr_b16 v[122:123], v6 offset:25600
v_cmp_ne_u32 s[44:45], 0, v10
v_mfma_f32_16x16x32_bf16 v[144:147], v[108:111], a[136:139], v[144:147]
buffer_load_dwordx4 v4, s[96:99], s88 offen offset:3072 lds
v_mfma_f32_16x16x32_bf16 v[148:151], v[108:111], a[140:143], v[148:151]
s_waitcnt lgkmcnt(4)
ds_read_b64_tr_b16 v[124:125], v6 offset:28672
v_cmp_ne_u32 s[46:47], 4, v10
v_mfma_f32_16x16x32_bf16 v[140:143], v[112:115], a[144:147], v[140:143]
s_add_u32 m0, s54, 135168
ds_read_b64_tr_b16 v[126:127], v6 offset:29696
v_mfma_f32_16x16x32_bf16 v[144:147], v[112:115], a[148:151], v[144:147]
buffer_load_dwordx4 v1, s[96:99], s57 offen offset:0 lds
v_mfma_f32_16x16x32_bf16 v[148:151], v[112:115], a[152:155], v[148:151]
s_waitcnt lgkmcnt(4)
ds_read_b64_tr_b16 v[64:65], v6 offset:32768
v_cmp_ne_u32 s[48:49], 8, v10
v_mfma_f32_16x16x32_bf16 v[140:143], v[116:119], a[156:159], v[140:143]
ds_read_b64_tr_b16 v[66:67], v6 offset:33792
v_cvt_pk_bf16_f32 v224, v128, v129
v_mfma_f32_16x16x32_bf16 v[144:147], v[116:119], a[160:163], v[144:147]
buffer_load_dwordx4 v2, s[96:99], s57 offen offset:1024 lds
v_mfma_f32_16x16x32_bf16 v[148:151], v[116:119], a[164:167], v[148:151]
s_waitcnt lgkmcnt(4)
ds_read_b64_tr_b16 v[68:69], v6 offset:36864
v_cvt_pk_bf16_f32 v225, v130, v131
v_mfma_f32_16x16x32_bf16 v[140:143], v[120:123], a[168:171], v[140:143]
ds_read_b64_tr_b16 v[70:71], v6 offset:37888
v_cvt_pk_bf16_f32 v226, v132, v133
v_mfma_f32_16x16x32_bf16 v[144:147], v[120:123], a[172:175], v[144:147]
buffer_load_dwordx4 v3, s[96:99], s57 offen offset:2048 lds
v_mfma_f32_16x16x32_bf16 v[148:151], v[120:123], a[176:179], v[148:151]
s_waitcnt lgkmcnt(4)
ds_read_b64_tr_b16 v[72:73], v6 offset:40960
v_cvt_pk_bf16_f32 v227, v134, v135
v_mfma_f32_16x16x32_bf16 v[140:143], v[124:127], a[180:183], v[140:143]
ds_read_b64_tr_b16 v[74:75], v6 offset:41984
v_cvt_pk_bf16_f32 v228, v136, v137
v_mfma_f32_16x16x32_bf16 v[144:147], v[124:127], a[184:187], v[144:147]
buffer_load_dwordx4 v4, s[96:99], s57 offen offset:3072 lds
v_mfma_f32_16x16x32_bf16 v[148:151], v[124:127], a[188:191], v[148:151]
s_waitcnt lgkmcnt(4)
ds_read_b64_tr_b16 v[76:77], v6 offset:45056
v_cvt_pk_bf16_f32 v229, v138, v139
v_mfma_f32_16x16x32_bf16 v[152:155], v[64:67], a[96:99], 0
s_waitcnt vmcnt(16)
s_barrier
v_mfma_f32_16x16x32_bf16 v[156:159], v[64:67], a[100:103], 0
ds_read_b64_tr_b16 v[78:79], v6 offset:46080
s_add_u32 m0, s54, 65536
s_nop 0
buffer_load_dwordx4 v1, s[96:99], s89 offen offset:0 lds
v_mfma_f32_16x16x32_bf16 v[160:163], v[64:67], a[104:107], 0
s_waitcnt lgkmcnt(4)
ds_read_b64_tr_b16 v[80:81], v6 offset:49152
v_mfma_f32_16x16x32_bf16 v[152:155], v[68:71], a[108:111], v[152:155]
ds_read_b64_tr_b16 v[82:83], v6 offset:50176
v_mfma_f32_16x16x32_bf16 v[156:159], v[68:71], a[112:115], v[156:159]
buffer_load_dwordx4 v2, s[96:99], s89 offen offset:1024 lds
v_mfma_f32_16x16x32_bf16 v[160:163], v[68:71], a[116:119], v[160:163]
s_waitcnt lgkmcnt(4)
ds_read_b64_tr_b16 v[84:85], v6 offset:53248
v_cvt_pk_bf16_f32 v176, v140, v141
v_mfma_f32_16x16x32_bf16 v[152:155], v[72:75], a[120:123], v[152:155]
s_add_u32 s57, s89, 36864
ds_read_b64_tr_b16 v[86:87], v6 offset:54272
v_mfma_f32_16x16x32_bf16 v[156:159], v[72:75], a[124:127], v[156:159]
buffer_load_dwordx4 v3, s[96:99], s89 offen offset:2048 lds
v_mfma_f32_16x16x32_bf16 v[160:163], v[72:75], a[128:131], v[160:163]
s_waitcnt lgkmcnt(4)
ds_read_b64_tr_b16 v[88:89], v6 offset:57344
v_cvt_pk_bf16_f32 v177, v142, v143
v_mfma_f32_16x16x32_bf16 v[152:155], v[76:79], a[132:135], v[152:155]
ds_read_b64_tr_b16 v[90:91], v6 offset:58368
v_cvt_pk_bf16_f32 v180, v144, v145
v_mfma_f32_16x16x32_bf16 v[156:159], v[76:79], a[136:139], v[156:159]
buffer_load_dwordx4 v4, s[96:99], s89 offen offset:3072 lds
v_mfma_f32_16x16x32_bf16 v[160:163], v[76:79], a[140:143], v[160:163]
s_waitcnt lgkmcnt(4)
ds_read_b64_tr_b16 v[92:93], v6 offset:61440
v_cvt_pk_bf16_f32 v181, v146, v147
v_mfma_f32_16x16x32_bf16 v[152:155], v[80:83], a[144:147], v[152:155]
s_add_u32 m0, s54, 69632
ds_read_b64_tr_b16 v[94:95], v6 offset:62464
v_mfma_f32_16x16x32_bf16 v[156:159], v[80:83], a[148:151], v[156:159]
buffer_load_dwordx4 v1, s[96:99], s57 offen offset:0 lds
v_mfma_f32_16x16x32_bf16 v[160:163], v[80:83], a[152:155], v[160:163]
s_waitcnt lgkmcnt(4)
ds_read_b64_tr_b16 v[96:97], v5 offset:32768
v_cvt_pk_bf16_f32 v184, v148, v149
v_mfma_f32_16x16x32_bf16 v[152:155], v[84:87], a[156:159], v[152:155]
ds_read_b64_tr_b16 v[98:99], v5 offset:33792
v_cvt_pk_bf16_f32 v185, v150, v151
v_mfma_f32_16x16x32_bf16 v[156:159], v[84:87], a[160:163], v[156:159]
buffer_load_dwordx4 v2, s[96:99], s57 offen offset:1024 lds
v_mfma_f32_16x16x32_bf16 v[160:163], v[84:87], a[164:167], v[160:163]
s_waitcnt lgkmcnt(4)
ds_read_b64_tr_b16 v[100:101], v5 offset:36864
v_mfma_f32_16x16x32_bf16 v[152:155], v[88:91], a[168:171], v[152:155]
ds_read_b64_tr_b16 v[102:103], v5 offset:37888
v_mfma_f32_16x16x32_bf16 v[156:159], v[88:91], a[172:175], v[156:159]
buffer_load_dwordx4 v3, s[96:99], s57 offen offset:2048 lds
v_mfma_f32_16x16x32_bf16 v[160:163], v[88:91], a[176:179], v[160:163]
s_waitcnt lgkmcnt(4)
ds_read_b64_tr_b16 v[104:105], v5 offset:40960
v_mfma_f32_16x16x32_bf16 v[152:155], v[92:95], a[180:183], v[152:155]
ds_read_b64_tr_b16 v[106:107], v5 offset:41984
v_mfma_f32_16x16x32_bf16 v[156:159], v[92:95], a[184:187], v[156:159]
buffer_load_dwordx4 v4, s[96:99], s57 offen offset:3072 lds
v_mfma_f32_16x16x32_bf16 v[160:163], v[92:95], a[188:191], v[160:163]
s_waitcnt lgkmcnt(4)
ds_read_b64_tr_b16 v[108:109], v5 offset:45056
v_mfma_f32_16x16x32_bf16 v[164:167], v[96:99], a[96:99], 0
s_waitcnt vmcnt(16)
s_barrier
v_mfma_f32_16x16x32_bf16 v[168:171], v[96:99], a[100:103], 0
ds_read_b64_tr_b16 v[110:111], v5 offset:46080
s_add_u32 m0, s54, 98304
s_nop 0
buffer_load_dwordx4 v1, s[96:99], s90 offen offset:0 lds
v_mfma_f32_16x16x32_bf16 v[172:175], v[96:99], a[104:107], 0
s_waitcnt lgkmcnt(4)
ds_read_b64_tr_b16 v[112:113], v5 offset:49152
v_mfma_f32_16x16x32_bf16 v[164:167], v[100:103], a[108:111], v[164:167]
ds_read_b64_tr_b16 v[114:115], v5 offset:50176
v_mfma_f32_16x16x32_bf16 v[168:171], v[100:103], a[112:115], v[168:171]
buffer_load_dwordx4 v2, s[96:99], s90 offen offset:1024 lds
v_mfma_f32_16x16x32_bf16 v[172:175], v[100:103], a[116:119], v[172:175]
s_waitcnt lgkmcnt(4)
ds_read_b64_tr_b16 v[116:117], v5 offset:53248
v_cvt_pk_bf16_f32 v178, v152, v153
v_mfma_f32_16x16x32_bf16 v[164:167], v[104:107], a[120:123], v[164:167]
s_add_u32 s57, s90, 36864
ds_read_b64_tr_b16 v[118:119], v5 offset:54272
v_mfma_f32_16x16x32_bf16 v[168:171], v[104:107], a[124:127], v[168:171]
buffer_load_dwordx4 v3, s[96:99], s90 offen offset:2048 lds
v_mfma_f32_16x16x32_bf16 v[172:175], v[104:107], a[128:131], v[172:175]
s_waitcnt lgkmcnt(4)
ds_read_b64_tr_b16 v[120:121], v5 offset:57344
v_cvt_pk_bf16_f32 v179, v154, v155
v_mfma_f32_16x16x32_bf16 v[164:167], v[108:111], a[132:135], v[164:167]
ds_read_b64_tr_b16 v[122:123], v5 offset:58368
v_cvt_pk_bf16_f32 v182, v156, v157
v_mfma_f32_16x16x32_bf16 v[168:171], v[108:111], a[136:139], v[168:171]
buffer_load_dwordx4 v4, s[96:99], s90 offen offset:3072 lds
v_mfma_f32_16x16x32_bf16 v[172:175], v[108:111], a[140:143], v[172:175]
s_waitcnt lgkmcnt(4)
ds_read_b64_tr_b16 v[124:125], v5 offset:61440
v_cvt_pk_bf16_f32 v183, v158, v159
v_mfma_f32_16x16x32_bf16 v[164:167], v[112:115], a[144:147], v[164:167]
s_add_u32 m0, s54, 102400
ds_read_b64_tr_b16 v[126:127], v5 offset:62464
v_mfma_f32_16x16x32_bf16 v[168:171], v[112:115], a[148:151], v[168:171]
buffer_load_dwordx4 v1, s[96:99], s57 offen offset:0 lds
v_mfma_f32_16x16x32_bf16 v[172:175], v[112:115], a[152:155], v[172:175]
s_waitcnt lgkmcnt(4)
ds_read_b64_tr_b16 v[64:65], v5 offset:0
v_cvt_pk_bf16_f32 v186, v160, v161
v_mfma_f32_16x16x32_bf16 v[164:167], v[116:119], a[156:159], v[164:167]
ds_read_b64_tr_b16 v[66:67], v5 offset:1024
v_cvt_pk_bf16_f32 v187, v162, v163
v_mfma_f32_16x16x32_bf16 v[168:171], v[116:119], a[160:163], v[168:171]
buffer_load_dwordx4 v2, s[96:99], s57 offen offset:1024 lds
v_mfma_f32_16x16x32_bf16 v[172:175], v[116:119], a[164:167], v[172:175]
s_waitcnt lgkmcnt(4)
ds_read_b64_tr_b16 v[68:69], v5 offset:4096
v_mfma_f32_16x16x32_bf16 v[164:167], v[120:123], a[168:171], v[164:167]
ds_read_b64_tr_b16 v[70:71], v5 offset:5120
v_mfma_f32_16x16x32_bf16 v[168:171], v[120:123], a[172:175], v[168:171]
buffer_load_dwordx4 v3, s[96:99], s57 offen offset:2048 lds
v_mfma_f32_16x16x32_bf16 v[172:175], v[120:123], a[176:179], v[172:175]
s_waitcnt lgkmcnt(4)
ds_read_b64_tr_b16 v[72:73], v5 offset:8192
v_mfma_f32_16x16x32_bf16 v[164:167], v[124:127], a[180:183], v[164:167]
ds_read_b64_tr_b16 v[74:75], v5 offset:9216
v_mfma_f32_16x16x32_bf16 v[168:171], v[124:127], a[184:187], v[168:171]
buffer_load_dwordx4 v4, s[96:99], s57 offen offset:3072 lds
v_mfma_f32_16x16x32_bf16 v[172:175], v[124:127], a[188:191], v[172:175]
s_waitcnt lgkmcnt(4)
ds_read_b64_tr_b16 v[76:77], v5 offset:12288
v_mfma_f32_16x16x32_bf16 v[128:131], v[64:67], a[96:99], 0
s_waitcnt vmcnt(16)
s_barrier
v_mfma_f32_16x16x32_bf16 v[132:135], v[64:67], a[100:103], 0
ds_read_b64_tr_b16 v[78:79], v5 offset:13312
s_add_u32 m0, s54, 32768
s_nop 0
buffer_load_dwordx4 v1, s[96:99], s91 offen offset:0 lds
v_mfma_f32_16x16x32_bf16 v[136:139], v[64:67], a[104:107], 0
s_waitcnt lgkmcnt(4)
ds_read_b64_tr_b16 v[80:81], v5 offset:16384
v_mfma_f32_16x16x32_bf16 v[128:131], v[68:71], a[108:111], v[128:131]
ds_read_b64_tr_b16 v[82:83], v5 offset:17408
v_mfma_f32_16x16x32_bf16 v[132:135], v[68:71], a[112:115], v[132:135]
buffer_load_dwordx4 v2, s[96:99], s91 offen offset:1024 lds
v_mfma_f32_16x16x32_bf16 v[136:139], v[68:71], a[116:119], v[136:139]
s_waitcnt lgkmcnt(4)
ds_read_b64_tr_b16 v[84:85], v5 offset:20480
v_cvt_pk_bf16_f32 v188, v164, v165
v_mfma_f32_16x16x32_bf16 v[128:131], v[72:75], a[120:123], v[128:131]
s_add_u32 s57, s91, 36864
ds_read_b64_tr_b16 v[86:87], v5 offset:21504
v_mfma_f32_16x16x32_bf16 v[132:135], v[72:75], a[124:127], v[132:135]
buffer_load_dwordx4 v3, s[96:99], s91 offen offset:2048 lds
v_mfma_f32_16x16x32_bf16 v[136:139], v[72:75], a[128:131], v[136:139]
s_waitcnt lgkmcnt(4)
ds_read_b64_tr_b16 v[88:89], v5 offset:24576
v_cvt_pk_bf16_f32 v189, v166, v167
v_mfma_f32_16x16x32_bf16 v[128:131], v[76:79], a[132:135], v[128:131]
ds_read_b64_tr_b16 v[90:91], v5 offset:25600
v_cvt_pk_bf16_f32 v192, v168, v169
v_mfma_f32_16x16x32_bf16 v[132:135], v[76:79], a[136:139], v[132:135]
buffer_load_dwordx4 v4, s[96:99], s91 offen offset:3072 lds
v_mfma_f32_16x16x32_bf16 v[136:139], v[76:79], a[140:143], v[136:139]
s_waitcnt lgkmcnt(4)
ds_read_b64_tr_b16 v[92:93], v5 offset:28672
v_cvt_pk_bf16_f32 v193, v170, v171
v_mfma_f32_16x16x32_bf16 v[128:131], v[80:83], a[144:147], v[128:131]
s_add_u32 m0, s54, 36864
ds_read_b64_tr_b16 v[94:95], v5 offset:29696
v_mfma_f32_16x16x32_bf16 v[132:135], v[80:83], a[148:151], v[132:135]
buffer_load_dwordx4 v1, s[96:99], s57 offen offset:0 lds
v_mfma_f32_16x16x32_bf16 v[136:139], v[80:83], a[152:155], v[136:139]
s_waitcnt lgkmcnt(4)
ds_read_b64_tr_b16 v[96:97], v7 offset:0
v_cvt_pk_bf16_f32 v196, v172, v173
v_mfma_f32_16x16x32_bf16 v[128:131], v[84:87], a[156:159], v[128:131]
ds_read_b64_tr_b16 v[98:99], v7 offset:1024
v_cvt_pk_bf16_f32 v197, v174, v175
v_mfma_f32_16x16x32_bf16 v[132:135], v[84:87], a[160:163], v[132:135]
buffer_load_dwordx4 v2, s[96:99], s57 offen offset:1024 lds
v_mfma_f32_16x16x32_bf16 v[136:139], v[84:87], a[164:167], v[136:139]
s_waitcnt lgkmcnt(4)
ds_read_b64_tr_b16 v[100:101], v7 offset:4096
v_mfma_f32_16x16x32_bf16 v[128:131], v[88:91], a[168:171], v[128:131]
ds_read_b64_tr_b16 v[102:103], v7 offset:5120
v_mfma_f32_16x16x32_bf16 v[132:135], v[88:91], a[172:175], v[132:135]
buffer_load_dwordx4 v3, s[96:99], s57 offen offset:2048 lds
v_mfma_f32_16x16x32_bf16 v[136:139], v[88:91], a[176:179], v[136:139]
s_waitcnt lgkmcnt(4)
ds_read_b64_tr_b16 v[104:105], v7 offset:8192
v_mfma_f32_16x16x32_bf16 v[128:131], v[92:95], a[180:183], v[128:131]
ds_read_b64_tr_b16 v[106:107], v7 offset:9216
v_mfma_f32_16x16x32_bf16 v[132:135], v[92:95], a[184:187], v[132:135]
buffer_load_dwordx4 v4, s[96:99], s57 offen offset:3072 lds
v_mfma_f32_16x16x32_bf16 v[136:139], v[92:95], a[188:191], v[136:139]
s_waitcnt lgkmcnt(4)
ds_read_b64_tr_b16 v[108:109], v7 offset:12288
v_mfma_f32_16x16x32_bf16 v[140:143], v[96:99], a[96:99], 0
ds_read_b64_tr_b16 v[110:111], v7 offset:13312
v_cvt_pk_bf16_f32 v190, v128, v129
v_mfma_f32_16x16x32_bf16 v[144:147], v[96:99], a[100:103], 0
buffer_store_dwordx4 v[224:227], v9, s[32:35], s55 offen offset:3072 sc1
v_mfma_f32_16x16x32_bf16 v[148:151], v[96:99], a[104:107], 0
s_waitcnt lgkmcnt(4)
ds_read_b64_tr_b16 v[112:113], v7 offset:16384
v_cvt_pk_bf16_f32 v191, v130, v131
v_mfma_f32_16x16x32_bf16 v[140:143], v[100:103], a[108:111], v[140:143]
ds_read_b64_tr_b16 v[114:115], v7 offset:17408
v_cvt_pk_bf16_f32 v194, v132, v133
v_mfma_f32_16x16x32_bf16 v[144:147], v[100:103], a[112:115], v[144:147]
buffer_store_dwordx2 v[228:229], v230, s[32:35], s40 offen offset:3072 sc1
v_mfma_f32_16x16x32_bf16 v[148:151], v[100:103], a[116:119], v[148:151]
s_waitcnt lgkmcnt(4)
ds_read_b64_tr_b16 v[116:117], v7 offset:20480
v_cvt_pk_bf16_f32 v195, v134, v135
v_mfma_f32_16x16x32_bf16 v[140:143], v[104:107], a[120:123], v[140:143]
ds_read_b64_tr_b16 v[118:119], v7 offset:21504
v_cvt_pk_bf16_f32 v198, v136, v137
v_mfma_f32_16x16x32_bf16 v[144:147], v[104:107], a[124:127], v[144:147]
s_mov_b64 exec, s[44:45]
buffer_store_dwordx4 v[176:179], v9, s[32:35], s55 offen offset:0 sc1
s_mov_b64 exec, -1
v_mfma_f32_16x16x32_bf16 v[148:151], v[104:107], a[128:131], v[148:151]
s_waitcnt lgkmcnt(4)
ds_read_b64_tr_b16 v[120:121], v7 offset:24576
v_cvt_pk_bf16_f32 v199, v138, v139
v_mfma_f32_16x16x32_bf16 v[140:143], v[108:111], a[132:135], v[140:143]
ds_read_b64_tr_b16 v[122:123], v7 offset:25600
v_mfma_f32_16x16x32_bf16 v[144:147], v[108:111], a[136:139], v[144:147]
s_mov_b64 exec, s[46:47]
buffer_store_dwordx4 v[180:183], v9, s[32:35], s55 offen offset:1024 sc1
s_mov_b64 exec, -1
v_mfma_f32_16x16x32_bf16 v[148:151], v[108:111], a[140:143], v[148:151]
s_waitcnt lgkmcnt(4)
ds_read_b64_tr_b16 v[124:125], v7 offset:28672
v_mfma_f32_16x16x32_bf16 v[140:143], v[112:115], a[144:147], v[140:143]
s_waitcnt vmcnt(20)
s_barrier
v_mfma_f32_16x16x32_bf16 v[144:147], v[112:115], a[148:151], v[144:147]
ds_read_b64_tr_b16 v[126:127], v7 offset:29696
v_mfma_f32_16x16x32_bf16 v[148:151], v[112:115], a[152:155], v[148:151]
s_waitcnt lgkmcnt(4)
s_mov_b64 exec, s[48:49]
buffer_store_dwordx4 v[184:187], v9, s[32:35], s55 offen offset:2048 sc1
s_mov_b64 exec, -1
v_mfma_f32_16x16x32_bf16 v[140:143], v[116:119], a[156:159], v[140:143]
ds_read_b64_tr_b16 v[64:65], v6 offset:0
v_mfma_f32_16x16x32_bf16 v[144:147], v[116:119], a[160:163], v[144:147]
ds_read_b64_tr_b16 v[66:67], v6 offset:1024
v_mfma_f32_16x16x32_bf16 v[148:151], v[116:119], a[164:167], v[148:151]
s_waitcnt lgkmcnt(4)
ds_read_b64_tr_b16 v[68:69], v6 offset:4096
v_mfma_f32_16x16x32_bf16 v[140:143], v[120:123], a[168:171], v[140:143]
s_mov_b64 exec, s[44:45]
buffer_store_dwordx4 v[188:191], v9, s[32:35], s40 offen offset:0 sc1
s_mov_b64 exec, -1
v_mfma_f32_16x16x32_bf16 v[144:147], v[120:123], a[172:175], v[144:147]
ds_read_b64_tr_b16 v[70:71], v6 offset:5120
v_mfma_f32_16x16x32_bf16 v[148:151], v[120:123], a[176:179], v[148:151]
s_waitcnt lgkmcnt(4)
ds_read_b64_tr_b16 v[72:73], v6 offset:8192
v_mfma_f32_16x16x32_bf16 v[140:143], v[124:127], a[180:183], v[140:143]
ds_read_b64_tr_b16 v[74:75], v6 offset:9216
v_mfma_f32_16x16x32_bf16 v[144:147], v[124:127], a[184:187], v[144:147]
s_mov_b64 exec, s[46:47]
buffer_store_dwordx4 v[192:195], v9, s[32:35], s40 offen offset:1024 sc1
s_mov_b64 exec, -1
v_mfma_f32_16x16x32_bf16 v[148:151], v[124:127], a[188:191], v[148:151]
s_waitcnt lgkmcnt(4)
ds_read_b64_tr_b16 v[76:77], v6 offset:12288
v_mfma_f32_16x16x32_bf16 v[152:155], v[64:67], a[96:99], 0
ds_read_b64_tr_b16 v[78:79], v6 offset:13312
v_cvt_pk_bf16_f32 v200, v140, v141
v_mfma_f32_16x16x32_bf16 v[156:159], v[64:67], a[100:103], 0
ds_read_b64_tr_b16 v[80:81], v6 offset:16384
v_cvt_pk_bf16_f32 v201, v142, v143
v_mfma_f32_16x16x32_bf16 v[160:163], v[64:67], a[104:107], 0
s_waitcnt lgkmcnt(5)
s_mov_b64 exec, s[48:49]
buffer_store_dwordx4 v[196:199], v9, s[32:35], s40 offen offset:2048 sc1
s_mov_b64 exec, -1
v_mfma_f32_16x16x32_bf16 v[152:155], v[68:71], a[108:111], v[152:155]
ds_read_b64_tr_b16 v[82:83], v6 offset:17408
v_cvt_pk_bf16_f32 v204, v144, v145
v_mfma_f32_16x16x32_bf16 v[156:159], v[68:71], a[112:115], v[156:159]
ds_read_b64_tr_b16 v[84:85], v6 offset:20480
v_cvt_pk_bf16_f32 v205, v146, v147
v_mfma_f32_16x16x32_bf16 v[160:163], v[68:71], a[116:119], v[160:163]
s_waitcnt lgkmcnt(5)
ds_read_b64_tr_b16 v[86:87], v6 offset:21504
v_cvt_pk_bf16_f32 v208, v148, v149
v_mfma_f32_16x16x32_bf16 v[152:155], v[72:75], a[120:123], v[152:155]
ds_read_b64_tr_b16 v[88:89], v6 offset:24576
v_cvt_pk_bf16_f32 v209, v150, v151
v_mfma_f32_16x16x32_bf16 v[156:159], v[72:75], a[124:127], v[156:159]
ds_read_b64_tr_b16 v[90:91], v6 offset:25600
v_mfma_f32_16x16x32_bf16 v[160:163], v[72:75], a[128:131], v[160:163]
s_waitcnt lgkmcnt(6)
ds_read_b64_tr_b16 v[92:93], v6 offset:28672
v_mfma_f32_16x16x32_bf16 v[152:155], v[76:79], a[132:135], v[152:155]
ds_read_b64_tr_b16 v[94:95], v6 offset:29696
v_mfma_f32_16x16x32_bf16 v[156:159], v[76:79], a[136:139], v[156:159]
v_mfma_f32_16x16x32_bf16 v[160:163], v[76:79], a[140:143], v[160:163]
s_waitcnt lgkmcnt(6)
v_mfma_f32_16x16x32_bf16 v[152:155], v[80:83], a[144:147], v[152:155]
s_waitcnt vmcnt(16)
s_barrier
v_mfma_f32_16x16x32_bf16 v[156:159], v[80:83], a[148:151], v[156:159]
ds_read_b64_tr_b16 v[96:97], v6 offset:32768
v_mfma_f32_16x16x32_bf16 v[160:163], v[80:83], a[152:155], v[160:163]
s_waitcnt lgkmcnt(5)
ds_read_b64_tr_b16 v[98:99], v6 offset:33792
v_mfma_f32_16x16x32_bf16 v[152:155], v[84:87], a[156:159], v[152:155]
ds_read_b64_tr_b16 v[100:101], v6 offset:36864
v_mfma_f32_16x16x32_bf16 v[156:159], v[84:87], a[160:163], v[156:159]
ds_read_b64_tr_b16 v[102:103], v6 offset:37888
v_mfma_f32_16x16x32_bf16 v[160:163], v[84:87], a[164:167], v[160:163]
s_waitcnt lgkmcnt(6)
ds_read_b64_tr_b16 v[104:105], v6 offset:40960
v_mfma_f32_16x16x32_bf16 v[152:155], v[88:91], a[168:171], v[152:155]
ds_read_b64_tr_b16 v[106:107], v6 offset:41984
v_mfma_f32_16x16x32_bf16 v[156:159], v[88:91], a[172:175], v[156:159]
ds_read_b64_tr_b16 v[108:109], v6 offset:45056
v_mfma_f32_16x16x32_bf16 v[160:163], v[88:91], a[176:179], v[160:163]
s_waitcnt lgkmcnt(7)
ds_read_b64_tr_b16 v[110:111], v6 offset:46080
v_mfma_f32_16x16x32_bf16 v[152:155], v[92:95], a[180:183], v[152:155]
ds_read_b64_tr_b16 v[112:113], v6 offset:49152
v_mfma_f32_16x16x32_bf16 v[156:159], v[92:95], a[184:187], v[156:159]
ds_read_b64_tr_b16 v[114:115], v6 offset:50176
v_mfma_f32_16x16x32_bf16 v[160:163], v[92:95], a[188:191], v[160:163]
s_waitcnt lgkmcnt(8)
ds_read_b64_tr_b16 v[116:117], v6 offset:53248
v_mfma_f32_16x16x32_bf16 v[164:167], v[96:99], a[96:99], 0
ds_read_b64_tr_b16 v[118:119], v6 offset:54272
v_cvt_pk_bf16_f32 v202, v152, v153
v_mfma_f32_16x16x32_bf16 v[168:171], v[96:99], a[100:103], 0
ds_read_b64_tr_b16 v[120:121], v6 offset:57344
v_cvt_pk_bf16_f32 v203, v154, v155
v_mfma_f32_16x16x32_bf16 v[172:175], v[96:99], a[104:107], 0
s_waitcnt lgkmcnt(9)
ds_read_b64_tr_b16 v[122:123], v6 offset:58368
v_cvt_pk_bf16_f32 v206, v156, v157
v_mfma_f32_16x16x32_bf16 v[164:167], v[100:103], a[108:111], v[164:167]
ds_read_b64_tr_b16 v[124:125], v6 offset:61440
v_cvt_pk_bf16_f32 v207, v158, v159
v_mfma_f32_16x16x32_bf16 v[168:171], v[100:103], a[112:115], v[168:171]
s_mov_b64 exec, s[44:45]
buffer_store_dwordx4 v[200:203], v9, s[32:35], s51 offen offset:0 sc1
s_mov_b64 exec, -1
v_mfma_f32_16x16x32_bf16 v[172:175], v[100:103], a[116:119], v[172:175]
s_waitcnt lgkmcnt(9)
ds_read_b64_tr_b16 v[126:127], v6 offset:62464
v_cvt_pk_bf16_f32 v210, v160, v161
v_mfma_f32_16x16x32_bf16 v[164:167], v[104:107], a[120:123], v[164:167]
v_cvt_pk_bf16_f32 v211, v162, v163
v_mfma_f32_16x16x32_bf16 v[168:171], v[104:107], a[124:127], v[168:171]
v_mfma_f32_16x16x32_bf16 v[172:175], v[104:107], a[128:131], v[172:175]
s_waitcnt lgkmcnt(8)
s_mov_b64 exec, s[46:47]
buffer_store_dwordx4 v[204:207], v9, s[32:35], s51 offen offset:1024 sc1
s_mov_b64 exec, -1
v_mfma_f32_16x16x32_bf16 v[164:167], v[108:111], a[132:135], v[164:167]
v_mfma_f32_16x16x32_bf16 v[168:171], v[108:111], a[136:139], v[168:171]
v_mfma_f32_16x16x32_bf16 v[172:175], v[108:111], a[140:143], v[172:175]
s_waitcnt lgkmcnt(6)
v_mfma_f32_16x16x32_bf16 v[164:167], v[112:115], a[144:147], v[164:167]
s_mov_b64 exec, s[48:49]
buffer_store_dwordx4 v[208:211], v9, s[32:35], s51 offen offset:2048 sc1
s_mov_b64 exec, -1
v_mfma_f32_16x16x32_bf16 v[168:171], v[112:115], a[148:151], v[168:171]
v_mfma_f32_16x16x32_bf16 v[172:175], v[112:115], a[152:155], v[172:175]
s_waitcnt lgkmcnt(4)
v_mfma_f32_16x16x32_bf16 v[164:167], v[116:119], a[156:159], v[164:167]
v_mfma_f32_16x16x32_bf16 v[168:171], v[116:119], a[160:163], v[168:171]
s_waitcnt vmcnt(11)
s_barrier
v_mfma_f32_16x16x32_bf16 v[172:175], v[116:119], a[164:167], v[172:175]
s_waitcnt lgkmcnt(2)
ds_read_b64_tr_b16 v[64:65], v5 offset:32768
ds_read_b64_tr_b16 v[66:67], v5 offset:33792
v_mfma_f32_16x16x32_bf16 v[164:167], v[120:123], a[168:171], v[164:167]
ds_read_b64_tr_b16 v[68:69], v5 offset:36864
v_mfma_f32_16x16x32_bf16 v[168:171], v[120:123], a[172:175], v[168:171]
ds_read_b64_tr_b16 v[70:71], v5 offset:37888
v_mfma_f32_16x16x32_bf16 v[172:175], v[120:123], a[176:179], v[172:175]
s_waitcnt lgkmcnt(4)
ds_read_b64_tr_b16 v[72:73], v5 offset:40960
v_mfma_f32_16x16x32_bf16 v[164:167], v[124:127], a[180:183], v[164:167]
ds_read_b64_tr_b16 v[74:75], v5 offset:41984
v_mfma_f32_16x16x32_bf16 v[168:171], v[124:127], a[184:187], v[168:171]
ds_read_b64_tr_b16 v[76:77], v5 offset:45056
v_mfma_f32_16x16x32_bf16 v[172:175], v[124:127], a[188:191], v[172:175]
s_waitcnt lgkmcnt(5)
ds_read_b64_tr_b16 v[78:79], v5 offset:46080
v_mfma_f32_16x16x32_bf16 v[128:131], v[64:67], a[96:99], 0
ds_read_b64_tr_b16 v[80:81], v5 offset:49152
v_cvt_pk_bf16_f32 v212, v164, v165
v_mfma_f32_16x16x32_bf16 v[132:135], v[64:67], a[100:103], 0
ds_read_b64_tr_b16 v[82:83], v5 offset:50176
v_cvt_pk_bf16_f32 v213, v166, v167
v_mfma_f32_16x16x32_bf16 v[136:139], v[64:67], a[104:107], 0
s_waitcnt lgkmcnt(6)
ds_read_b64_tr_b16 v[84:85], v5 offset:53248
v_cvt_pk_bf16_f32 v216, v168, v169
v_mfma_f32_16x16x32_bf16 v[128:131], v[68:71], a[108:111], v[128:131]
ds_read_b64_tr_b16 v[86:87], v5 offset:54272
v_cvt_pk_bf16_f32 v217, v170, v171
v_mfma_f32_16x16x32_bf16 v[132:135], v[68:71], a[112:115], v[132:135]
ds_read_b64_tr_b16 v[88:89], v5 offset:57344
v_cvt_pk_bf16_f32 v220, v172, v173
v_mfma_f32_16x16x32_bf16 v[136:139], v[68:71], a[116:119], v[136:139]
s_waitcnt lgkmcnt(7)
ds_read_b64_tr_b16 v[90:91], v5 offset:58368
v_cvt_pk_bf16_f32 v221, v174, v175
v_mfma_f32_16x16x32_bf16 v[128:131], v[72:75], a[120:123], v[128:131]
ds_read_b64_tr_b16 v[92:93], v5 offset:61440
v_mfma_f32_16x16x32_bf16 v[132:135], v[72:75], a[124:127], v[132:135]
ds_read_b64_tr_b16 v[94:95], v5 offset:62464
v_mfma_f32_16x16x32_bf16 v[136:139], v[72:75], a[128:131], v[136:139]
s_waitcnt lgkmcnt(8)
v_mfma_f32_16x16x32_bf16 v[128:131], v[76:79], a[132:135], v[128:131]
v_mfma_f32_16x16x32_bf16 v[132:135], v[76:79], a[136:139], v[132:135]
v_mfma_f32_16x16x32_bf16 v[136:139], v[76:79], a[140:143], v[136:139]
s_waitcnt lgkmcnt(6)
v_mfma_f32_16x16x32_bf16 v[128:131], v[80:83], a[144:147], v[128:131]
s_waitcnt lgkmcnt(4)
v_mfma_f32_16x16x32_bf16 v[128:131], v[84:87], a[156:159], v[128:131]
s_waitcnt lgkmcnt(2)
v_mfma_f32_16x16x32_bf16 v[128:131], v[88:91], a[168:171], v[128:131]
s_waitcnt lgkmcnt(0)
v_mfma_f32_16x16x32_bf16 v[128:131], v[92:95], a[180:183], v[128:131]
v_mfma_f32_16x16x32_bf16 v[132:135], v[80:83], a[148:151], v[132:135]
v_mfma_f32_16x16x32_bf16 v[132:135], v[84:87], a[160:163], v[132:135]
v_mfma_f32_16x16x32_bf16 v[132:135], v[88:91], a[172:175], v[132:135]
s_nop 4
v_cvt_pk_bf16_f32 v214, v128, v129
v_cvt_pk_bf16_f32 v215, v130, v131
v_mfma_f32_16x16x32_bf16 v[132:135], v[92:95], a[184:187], v[132:135]
s_mov_b64 exec, s[44:45]
buffer_store_dwordx4 v[212:215], v9, s[32:35], s59 offen offset:0 sc1
s_mov_b64 exec, -1
v_mfma_f32_16x16x32_bf16 v[136:139], v[80:83], a[152:155], v[136:139]
v_mfma_f32_16x16x32_bf16 v[136:139], v[84:87], a[164:167], v[136:139]
v_mfma_f32_16x16x32_bf16 v[136:139], v[88:91], a[176:179], v[136:139]
s_nop 3
v_cvt_pk_bf16_f32 v218, v132, v133
v_cvt_pk_bf16_f32 v219, v134, v135
v_mfma_f32_16x16x32_bf16 v[136:139], v[92:95], a[188:191], v[136:139]
s_mov_b64 exec, s[46:47]
buffer_store_dwordx4 v[216:219], v9, s[32:35], s59 offen offset:1024 sc1
s_mov_b64 exec, -1
s_nop 6
v_cvt_pk_bf16_f32 v222, v136, v137
v_cvt_pk_bf16_f32 v223, v138, v139
s_mov_b64 exec, s[48:49]
buffer_store_dwordx4 v[220:223], v9, s[32:35], s59 offen offset:2048 sc1
s_mov_b64 exec, -1
v_mov_b32 v12, s13
v_mov_b32 v13, s13
v_mov_b32 v14, s13
v_mov_b32 v15, s13
v_lshrrev_b32 v56, 4, v0
v_lshlrev_b32 v35, 7, v56
v_add_u32 v35, 98304, v35
v_and_b32 v57, 15, v0
v_lshlrev_b32 v36, 7, v57
v_add_u32 v36, 98304, v36
v_add3_u32 v28, v56, s38, 0
v_add3_u32 v29, v56, s38, 4
v_add3_u32 v30, v56, s38, 8
v_add3_u32 v31, v56, s38, 12
v_and_b32 v28, 15, v28
v_and_b32 v29, 15, v29
v_and_b32 v30, 15, v30
v_and_b32 v31, 15, v31
v_mul_u32_u24 v28, 69888, v28
v_mul_u32_u24 v29, 69888, v29
v_mul_u32_u24 v30, 69888, v30
v_mul_u32_u24 v31, 69888, v31
v_lshl_add_u32 v28, v57, 4, v28
v_lshl_add_u32 v29, v57, 4, v29
v_lshl_add_u32 v30, v57, 4, v30
v_lshl_add_u32 v31, v57, 4, v31
v_and_b32 v34, 3, v0
v_mul_u32_u24 v34, 1152, v34
v_and_b32 v32, 12, v0
v_lshl_add_u32 v34, v32, 1, v34
v_add3_u32 v32, v56, s52, 1
v_add_u32 v33, 4, v32
v_subrev_u32 v57, 9, v32
v_min_u32 v32, v32, v57
v_lshl_add_u32 v32, v32, 7, v34
v_subrev_u32 v57, 9, v33
v_min_u32 v33, v33, v57
v_lshl_add_u32 v33, v33, 7, v34
v_mul_u32_u24 v56, 18432, v56
v_add_u32 v34, v34, v56
v_mov_b32 v232, 0x3f80
v_and_b32 v56, 1, v0
v_lshlrev_b32 v56, 4, v56
v_lshlrev_b32 v56, v56, v232
v_bfe_u32 v57, v0, 1, 3
v_cmp_eq_u32 s[84:85], 0, v57
v_cmp_eq_u32 s[86:87], 1, v57
v_cmp_eq_u32 s[88:89], 2, v57
v_cmp_eq_u32 s[90:91], 3, v57
v_cndmask_b32 v248, 0, v56, s[84:85]
v_cndmask_b32 v249, 0, v56, s[86:87]
v_cndmask_b32 v250, 0, v56, s[88:89]
v_cndmask_b32 v251, 0, v56, s[90:91]
v_cmp_eq_u32 s[84:85], 4, v57
v_cmp_eq_u32 s[86:87], 5, v57
v_cmp_eq_u32 s[88:89], 6, v57
v_cmp_eq_u32 s[90:91], 7, v57
v_cndmask_b32 v252, 0, v56, s[84:85]
v_cndmask_b32 v253, 0, v56, s[86:87]
v_cndmask_b32 v254, 0, v56, s[88:89]
v_cndmask_b32 v255, 0, v56, s[90:91]
s_mov_b32 s12, 4000
v_mov_b32 v56, 0
s_lshl_b32 s39, s36, 12
v_add_u32 v58, s39, v9
s_and_b32 s58, s1, 3
s_lshl_b32 s58, s58, 8
s_add_u32 s39, s39, s58
v_and_b32 v59, 15, v0
v_lshl_add_u32 v59, v59, 4, s39
s_not_b64 exec, s[44:45]
ds_write_b128 v58, v[176:179] offset:4096
ds_write_b128 v58, v[188:191] offset:5120
ds_write_b128 v58, v[200:203] offset:6144
ds_write_b128 v58, v[212:215] offset:7168
s_not_b64 exec, s[46:47]
ds_write_b128 v58, v[180:183] offset:4096
ds_write_b128 v58, v[192:195] offset:5120
ds_write_b128 v58, v[204:207] offset:6144
ds_write_b128 v58, v[216:219] offset:7168
s_not_b64 exec, s[48:49]
ds_write_b128 v58, v[184:187] offset:4096
ds_write_b128 v58, v[196:199] offset:5120
ds_write_b128 v58, v[208:211] offset:6144
ds_write_b128 v58, v[220:223] offset:7168
s_mov_b64 exec, -1
s_cmp_lg_u32 s36, 0
s_waitcnt vmcnt(0) lgkmcnt(0)
s_barrier
s_cbranch_scc1 T_OWN
s_mov_b64 exec, 0xff
buffer_store_dwordx4 v[12:15], v26, s[32:35], s9 offen offset:0 sc1
T_OWN:
s_mov_b64 exec, 0xffff
s_cmp_ge_u32 s1, 12
s_cbranch_scc1 T_OW3
ds_read_b128 v[64:67], v59 offset:4096
ds_read_b128 v[80:83], v59 offset:5120
ds_read_b128 v[96:99], v59 offset:6144
ds_read_b128 v[112:115], v59 offset:7168
T_OW3:
s_cmp_lg_u32 s36, 0
s_cbranch_scc1 T_BARX
s_mov_b64 exec, 0xffff
T_POLL:
buffer_load_dword v40, v36, s[32:35], s8 offen sc1
s_waitcnt vmcnt(0)
v_xor_b32 v40, s13, v40
v_cmp_ge_u32 vcc, 1, v40
s_nop 0
s_cmp_eq_u32 vcc_lo, 0xffff
s_cbranch_scc0 T_MORE
T_PUB:
v_mov_b32 v40, vcc_lo
ds_write_b32 v56, v40
s_waitcnt lgkmcnt(0)
T_BARX:
s_mov_b64 exec, -1
T_BAR:
s_barrier
ds_read_b32 v40, v56
s_waitcnt lgkmcnt(0)
v_cmp_eq_u32 vcc, 0xffff, v40
s_nop 0
s_cmp_eq_u32 vcc_lo, 0
s_cbranch_scc1 T_END
buffer_load_dword v40, v36, s[32:35], s8 offen sc1
s_cmp_ge_u32 s1, 12
s_cbranch_scc1 T_LH
s_mov_b32 exec_lo, 0xffff0000
buffer_load_dwordx4 v[64:67], v28, s[32:35], s41 offen sc1
buffer_load_dwordx4 v[80:83], v28, s[32:35], s42 offen sc1
s_mov_b32 exec_lo, -1
buffer_load_dwordx4 v[68:71], v29, s[32:35], s41 offen sc1
buffer_load_dwordx4 v[84:87], v29, s[32:35], s42 offen sc1
buffer_load_dwordx4 v[72:75], v30, s[32:35], s41 offen sc1
buffer_load_dwordx4 v[88:91], v30, s[32:35], s42 offen sc1
buffer_load_dwordx4 v[76:79], v31, s[32:35], s41 offen sc1
buffer_load_dwordx4 v[92:95], v31, s[32:35], s42 offen sc1
s_mov_b32 exec_lo, 0xffff0000
buffer_load_dwordx4 v[96:99], v28, s[32:35], s53 offen sc1
buffer_load_dwordx4 v[112:115], v28, s[32:35], s56 offen sc1
s_mov_b32 exec_lo, -1
buffer_load_dwordx4 v[100:103], v29, s[32:35], s53 offen sc1
buffer_load_dwordx4 v[116:119], v29, s[32:35], s56 offen sc1
buffer_load_dwordx4 v[104:107], v30, s[32:35], s53 offen sc1
buffer_load_dwordx4 v[120:123], v30, s[32:35], s56 offen sc1
buffer_load_dwordx4 v[108:111], v31, s[32:35], s53 offen sc1
buffer_load_dwordx4 v[124:127], v31, s[32:35], s56 offen sc1
T_L2:
s_or_b32 s13, s13, 1
s_waitcnt vmcnt(8)
v_cmp_eq_u32 s[4:5], s13, v40
T_RED:
v_mfma_f32_16x16x32_bf16 v[232:235], v[248:251], v[64:67], 0
v_mfma_f32_16x16x32_bf16 v[232:235], v[248:251], v[68:71], v[232:235]
v_mfma_f32_16x16x32_bf16 v[232:235], v[248:251], v[72:75], v[232:235]
v_mfma_f32_16x16x32_bf16 v[232:235], v[248:251], v[76:79], v[232:235]
v_mfma_f32_16x16x32_bf16 v[232:235], v[252:255], v[80:83], v[232:235]
v_mfma_f32_16x16x32_bf16 v[232:235], v[252:255], v[84:87], v[232:235]
v_mfma_f32_16x16x32_bf16 v[232:235], v[252:255], v[88:91], v[232:235]
v_mfma_f32_16x16x32_bf16 v[232:235], v[252:255], v[92:95], v[232:235]
s_cmp_ge_u32 s1, 12
s_cbranch_scc1 T_Z
s_waitcnt vmcnt(6)
v_mfma_f32_16x16x32_bf16 v[236:239], v[248:251], v[96:99], 0
v_mfma_f32_16x16x32_bf16 v[236:239], v[252:255], v[112:115], v[236:239]
s_waitcnt vmcnt(4)
v_mfma_f32_16x16x32_bf16 v[236:239], v[248:251], v[100:103], v[236:239]
v_mfma_f32_16x16x32_bf16 v[236:239], v[252:255], v[116:119], v[236:239]
s_waitcnt vmcnt(2)
v_mfma_f32_16x16x32_bf16 v[236:239], v[248:251], v[104:107], v[236:239]
v_mfma_f32_16x16x32_bf16 v[236:239], v[252:255], v[120:123], v[236:239]
s_waitcnt vmcnt(0)
v_mfma_f32_16x16x32_bf16 v[236:239], v[248:251], v[108:111], v[236:239]
v_mfma_f32_16x16x32_bf16 v[236:239], v[252:255], v[124:127], v[236:239]
v_cvt_pk_bf16_f32 v232, v232, v233
v_cvt_pk_bf16_f32 v233, v234, v235
buffer_store_dwordx2 v[232:233], v32, s[16:19], s82 offen
s_or_b32 s39, s1, s36
s_nop 3
v_cvt_pk_bf16_f32 v236, v236, v237
v_cvt_pk_bf16_f32 v237, v238, v239
buffer_store_dwordx2 v[236:237], v33, s[16:19], s82 offen
s_cbranch_scc1 T_NEXT
v_mov_b32 v12, s3
s_mov_b64 exec, 0xff
buffer_store_dwordx4 v[12:15], v26, s[32:35], s8 offen offset:2048 sc1
s_mov_b64 exec, -1
T_NEXT:
s_bitset0_b32 s4, s1
s_and_b32 s4, s4, 0xffff
s_cbranch_scc0 T_END
s_ff1_i32_b32 s1, s4
s_waitcnt vmcnt(0)
s_mul_i32 s41, s37, 1118208
s_lshl4_add_u32 s39, s36, s1
s_lshl_b32 s39, s39, 8
s_add_u32 s41, s41, s39
s_add_u32 s41, s41, 8388608
s_add_u32 s42, s41, 16384
s_add_u32 s53, s41, 32768
s_add_u32 s56, s41, 49152
s_bfe_u32 s39, s1, 0x10001
s_xor_b32 s39, s39, s1
s_and_b32 s39, s39, 3
s_mul_i32 s39, s39, 4608
s_mul_i32 s82, s37, 55296
s_add_u32 s82, s82, s39
s_lshl_b32 s39, s36, 5
s_add_u32 s82, s82, s39
s_lshr_b32 s39, s1, 2
s_mul_i32 s58, s39, 18432
s_lshl_b32 s0, s52, 7
s_cmp_eq_u32 s39, 3
s_cselect_b32 s58, s0, s58
s_add_u32 s82, s82, s58
s_cmp_ge_u32 s1, 12
s_cbranch_scc1 T_FH
buffer_load_dwordx4 v[64:67], v28, s[32:35], s41 offen sc1
buffer_load_dwordx4 v[68:71], v29, s[32:35], s41 offen sc1
buffer_load_dwordx4 v[72:75], v30, s[32:35], s41 offen sc1
buffer_load_dwordx4 v[76:79], v31, s[32:35], s41 offen sc1
buffer_load_dwordx4 v[80:83], v28, s[32:35], s42 offen sc1
buffer_load_dwordx4 v[84:87], v29, s[32:35], s42 offen sc1
buffer_load_dwordx4 v[88:91], v30, s[32:35], s42 offen sc1
buffer_load_dwordx4 v[92:95], v31, s[32:35], s42 offen sc1
buffer_load_dwordx4 v[96:99], v28, s[32:35], s53 offen sc1
buffer_load_dwordx4 v[100:103], v29, s[32:35], s53 offen sc1
buffer_load_dwordx4 v[104:107], v30, s[32:35], s53 offen sc1
buffer_load_dwordx4 v[108:111], v31, s[32:35], s53 offen sc1
buffer_load_dwordx4 v[112:115], v28, s[32:35], s56 offen sc1
buffer_load_dwordx4 v[116:119], v29, s[32:35], s56 offen sc1
buffer_load_dwordx4 v[120:123], v30, s[32:35], s56 offen sc1
buffer_load_dwordx4 v[124:127], v31, s[32:35], s56 offen sc1
s_waitcnt vmcnt(0)
s_branch T_RED
T_FH:
buffer_load_dwordx4 v[64:67], v28, s[32:35], s41 offen sc1
buffer_load_dwordx4 v[68:71], v29, s[32:35], s41 offen sc1
buffer_load_dwordx4 v[72:75], v30, s[32:35], s41 offen sc1
buffer_load_dwordx4 v[76:79], v31, s[32:35], s41 offen sc1
v_and_b32 v57, 15, v0
s_and_b32 s39, s1, 3
v_lshlrev_b32 v57, 3, v57
s_lshl_b32 s39, s39, 7
s_sub_u32 s39, s42, s39
v_sub_u32 v96, v28, v57
v_sub_u32 v97, v29, v57
v_sub_u32 v98, v30, v57
v_sub_u32 v99, v31, v57
buffer_load_dwordx2 v[80:81], v96, s[32:35], s39 offen sc1
buffer_load_dwordx2 v[84:85], v97, s[32:35], s39 offen sc1
buffer_load_dwordx2 v[88:89], v98, s[32:35], s39 offen sc1
buffer_load_dwordx2 v[92:93], v99, s[32:35], s39 offen sc1
v_mov_b32 v82, 0
v_mov_b32 v83, 0
v_mov_b32 v86, 0
v_mov_b32 v87, 0
v_mov_b32 v90, 0
v_mov_b32 v91, 0
v_mov_b32 v94, 0
v_mov_b32 v95, 0
s_waitcnt vmcnt(0)
s_branch T_RED
T_LH:
buffer_load_dwordx4 v[64:67], v28, s[32:35], s41 offen sc1
buffer_load_dwordx4 v[68:71], v29, s[32:35], s41 offen sc1
buffer_load_dwordx4 v[72:75], v30, s[32:35], s41 offen sc1
buffer_load_dwordx4 v[76:79], v31, s[32:35], s41 offen sc1
v_and_b32 v57, 15, v0
s_and_b32 s39, s1, 3
v_lshlrev_b32 v57, 3, v57
s_lshl_b32 s39, s39, 7
s_sub_u32 s39, s42, s39
v_sub_u32 v96, v28, v57
v_sub_u32 v97, v29, v57
v_sub_u32 v98, v30, v57
v_sub_u32 v99, v31, v57
buffer_load_dwordx2 v[80:81], v96, s[32:35], s39 offen sc1
buffer_load_dwordx2 v[84:85], v97, s[32:35], s39 offen sc1
buffer_load_dwordx2 v[88:89], v98, s[32:35], s39 offen sc1
buffer_load_dwordx2 v[92:93], v99, s[32:35], s39 offen sc1
v_mov_b32 v82, 0
v_mov_b32 v83, 0
v_mov_b32 v86, 0
v_mov_b32 v87, 0
v_mov_b32 v90, 0
v_mov_b32 v91, 0
v_mov_b32 v94, 0
v_mov_b32 v95, 0
s_waitcnt vmcnt(0)
s_branch T_L2
T_Z:
s_mov_b32 exec_hi, 0xffff
s_nop 7
v_cvt_pk_bf16_f32 v232, v232, v233
v_cvt_pk_bf16_f32 v233, v234, v235
buffer_store_dwordx2 v[232:233], v34, s[16:19], s82 offen
s_mov_b32 exec_hi, -1
s_branch T_NEXT
T_MORE:
s_sub_u32 s12, s12, 1
s_cmp_gt_i32 s12, 0
s_cbranch_scc1 T_POLL
s_cmp_lg_u32 s12, 0
s_cbranch_scc1 T_PUB
s_cmp_ge_u32 s1, 12
s_cbranch_scc1 T_GV
s_mov_b64 exec, -1
v_lshrrev_b32 v60, 4, v0
v_lshl_add_u32 v61, v60, 12, v59
ds_read_b128 v[128:131], v61 offset:4096
ds_read_b128 v[132:135], v61 offset:5120
ds_read_b128 v[136:139], v61 offset:6144
ds_read_b128 v[140:143], v61 offset:7168
v_and_b32 v61, 15, v0
s_mul_i32 s39, s38, 69888
v_lshl_add_u32 v61, v61, 4, s39
v_lshl_add_u32 v61, v60, 12, v61
s_waitcnt lgkmcnt(0)
buffer_store_dwordx4 v[128:131], v61, s[32:35], s41 offen sc1
buffer_store_dwordx4 v[132:135], v61, s[32:35], s42 offen sc1
buffer_store_dwordx4 v[136:139], v61, s[32:35], s53 offen sc1
buffer_store_dwordx4 v[140:143], v61, s[32:35], s56 offen sc1
T_GV:
s_waitcnt vmcnt(0)
v_or_b32 v12, 1, v12
s_mov_b64 exec, 0xff
buffer_store_dwordx4 v[12:15], v26, s[32:35], s9 offen offset:0 sc1
s_mov_b64 exec, -1
s_mov_b64 exec, 0xffff
s_waitcnt vmcnt(0)
s_branch T_POLL
T_END:
K1_EXIT:
s_endpgm
K1_SLOW:
s_nop 15
s_waitcnt vmcnt(0) lgkmcnt(0)
s_barrier
s_add_u32 m0, s54, 32768
s_nop 0
buffer_load_dwordx4 v13, s[24:27], s43 offen offset:0 lds
buffer_load_dwordx4 v13, s[24:27], s43 offen offset:1024 lds
buffer_load_dwordx4 v13, s[24:27], s43 offen offset:2048 lds
buffer_load_dwordx4 v13, s[24:27], s43 offen offset:3072 lds
s_add_u32 m0, s54, 36864
s_nop 0
buffer_load_dwordx4 v13, s[24:27], s44 offen offset:0 lds
buffer_load_dwordx4 v13, s[24:27], s44 offen offset:1024 lds
buffer_load_dwordx4 v13, s[24:27], s44 offen offset:2048 lds
buffer_load_dwordx4 v13, s[24:27], s44 offen offset:3072 lds
s_add_u32 m0, s54, 0
s_nop 0
buffer_load_dwordx4 v13, s[24:27], s45 offen offset:0 lds
buffer_load_dwordx4 v13, s[24:27], s45 offen offset:1024 lds
buffer_load_dwordx4 v13, s[24:27], s45 offen offset:2048 lds
buffer_load_dwordx4 v13, s[24:27], s45 offen offset:3072 lds
s_add_u32 m0, s54, 4096
s_nop 0
buffer_load_dwordx4 v13, s[24:27], s46 offen offset:0 lds
buffer_load_dwordx4 v13, s[24:27], s46 offen offset:1024 lds
buffer_load_dwordx4 v13, s[24:27], s46 offen offset:2048 lds
buffer_load_dwordx4 v13, s[24:27], s46 offen offset:3072 lds
s_add_u32 m0, s54, 65536
s_nop 0
buffer_load_dwordx4 v13, s[24:27], s47 offen offset:0 lds
buffer_load_dwordx4 v13, s[24:27], s47 offen offset:1024 lds
buffer_load_dwordx4 v13, s[24:27], s47 offen offset:2048 lds
buffer_load_dwordx4 v13, s[24:27], s47 offen offset:3072 lds
s_add_u32 m0, s54, 69632
s_nop 0
buffer_load_dwordx4 v13, s[24:27], s48 offen offset:0 lds
buffer_load_dwordx4 v13, s[24:27], s48 offen offset:1024 lds
buffer_load_dwordx4 v13, s[24:27], s48 offen offset:2048 lds
buffer_load_dwordx4 v13, s[24:27], s48 offen offset:3072 lds
v_subrev_u32 v31, 0x8000, v31
v_subrev_u32 v32, 0x8000, v32
v_subrev_u32 v33, 0x8000, v33
v_subrev_u32 v34, 0x8000, v34
v_and_b32 v48, 31, v0
v_lshrrev_b32 v49, 5, v0
v_lshlrev_b32 v49, 4, v49
v_lshl_add_u32 v48, v48, 8, v49
buffer_load_dwordx4 a[96:99], v48, s[20:23], s43 offen offset:0
buffer_load_dwordx4 a[100:103], v48, s[20:23], s43 offen offset:32
buffer_load_dwordx4 a[104:107], v48, s[20:23], s43 offen offset:64
buffer_load_dwordx4 a[108:111], v48, s[20:23], s43 offen offset:96
buffer_load_dwordx4 a[112:115], v48, s[20:23], s43 offen offset:128
buffer_load_dwordx4 a[116:119], v48, s[20:23], s43 offen offset:160
buffer_load_dwordx4 a[120:123], v48, s[20:23], s43 offen offset:192
buffer_load_dwordx4 a[124:127], v48, s[20:23], s43 offen offset:224
buffer_load_dwordx4 a[128:131], v48, s[20:23], s45 offen offset:0
buffer_load_dwordx4 a[132:135], v48, s[20:23], s45 offen offset:32
buffer_load_dwordx4 a[136:139], v48, s[20:23], s45 offen offset:64
buffer_load_dwordx4 a[140:143], v48, s[20:23], s45 offen offset:96
buffer_load_dwordx4 a[144:147], v48, s[20:23], s45 offen offset:128
buffer_load_dwordx4 a[148:151], v48, s[20:23], s45 offen offset:160
buffer_load_dwordx4 a[152:155], v48, s[20:23], s45 offen offset:192
buffer_load_dwordx4 a[156:159], v48, s[20:23], s45 offen offset:224
buffer_load_dwordx4 a[160:163], v48, s[20:23], s47 offen offset:0
buffer_load_dwordx4 a[164:167], v48, s[20:23], s47 offen offset:32
buffer_load_dwordx4 a[168:171], v48, s[20:23], s47 offen offset:64
buffer_load_dwordx4 a[172:175], v48, s[20:23], s47 offen offset:96
buffer_load_dwordx4 a[176:179], v48, s[20:23], s47 offen offset:128
buffer_load_dwordx4 a[180:183], v48, s[20:23], s47 offen offset:160
buffer_load_dwordx4 a[184:187], v48, s[20:23], s47 offen offset:192
buffer_load_dwordx4 a[188:191], v48, s[20:23], s47 offen offset:224
buffer_load_dwordx4 a[192:195], v48, s[20:23], s49 offen offset:0
buffer_load_dwordx4 a[196:199], v48, s[20:23], s49 offen offset:32
buffer_load_dwordx4 a[200:203], v48, s[20:23], s49 offen offset:64
buffer_load_dwordx4 a[204:207], v48, s[20:23], s49 offen offset:96
buffer_load_dwordx4 a[208:211], v48, s[20:23], s49 offen offset:128
buffer_load_dwordx4 a[212:215], v48, s[20:23], s49 offen offset:160
buffer_load_dwordx4 a[216:219], v48, s[20:23], s49 offen offset:192
buffer_load_dwordx4 a[220:223], v48, s[20:23], s49 offen offset:224
s_waitcnt vmcnt(0)
v_mfma_f32_32x32x16_bf16 v[64:79], a[96:99], a[0:3], 0
v_mfma_f32_32x32x16_bf16 v[64:79], a[100:103], a[4:7], v[64:79]
v_mfma_f32_32x32x16_bf16 v[64:79], a[104:107], a[8:11], v[64:79]
v_mfma_f32_32x32x16_bf16 v[64:79], a[108:111], a[12:15], v[64:79]
v_mfma_f32_32x32x16_bf16 v[64:79], a[112:115], a[16:19], v[64:79]
v_mfma_f32_32x32x16_bf16 v[64:79], a[116:119], a[20:23], v[64:79]
v_mfma_f32_32x32x16_bf16 v[64:79], a[120:123], a[24:27], v[64:79]
v_mfma_f32_32x32x16_bf16 v[64:79], a[124:127], a[28:31], v[64:79]
v_mfma_f32_32x32x16_bf16 v[80:95], a[96:99], a[32:35], 0
v_mfma_f32_32x32x16_bf16 v[80:95], a[100:103], a[36:39], v[80:95]
v_mfma_f32_32x32x16_bf16 v[80:95], a[104:107], a[40:43], v[80:95]
v_mfma_f32_32x32x16_bf16 v[80:95], a[108:111], a[44:47], v[80:95]
v_mfma_f32_32x32x16_bf16 v[80:95], a[112:115], a[48:51], v[80:95]
v_mfma_f32_32x32x16_bf16 v[80:95], a[116:119], a[52:55], v[80:95]
v_mfma_f32_32x32x16_bf16 v[80:95], a[120:123], a[56:59], v[80:95]
v_mfma_f32_32x32x16_bf16 v[80:95], a[124:127], a[60:63], v[80:95]
v_mfma_f32_32x32x16_bf16 v[96:111], a[96:99], a[64:67], 0
v_mfma_f32_32x32x16_bf16 v[96:111], a[100:103], a[68:71], v[96:111]
v_mfma_f32_32x32x16_bf16 v[96:111], a[104:107], a[72:75], v[96:111]
v_mfma_f32_32x32x16_bf16 v[96:111], a[108:111], a[76:79], v[96:111]
v_mfma_f32_32x32x16_bf16 v[96:111], a[112:115], a[80:83], v[96:111]
v_mfma_f32_32x32x16_bf16 v[96:111], a[116:119], a[84:87], v[96:111]
v_mfma_f32_32x32x16_bf16 v[96:111], a[120:123], a[88:91], v[96:111]
v_mfma_f32_32x32x16_bf16 v[96:111], a[124:127], a[92:95], v[96:111]
v_max_f32 v44, v64, v65
v_max3_f32 v44, v44, v66, v67
v_max3_f32 v44, v44, v68, v69
v_max3_f32 v44, v44, v70, v71
v_max3_f32 v44, v44, v72, v73
v_max3_f32 v44, v44, v74, v75
v_max3_f32 v44, v44, v76, v77
v_max3_f32 v44, v44, v78, v79
v_max_f32 v45, v80, v81
v_max3_f32 v45, v45, v82, v83
v_max3_f32 v45, v45, v84, v85
v_max3_f32 v45, v45, v86, v87
v_max3_f32 v45, v45, v88, v89
v_max3_f32 v45, v45, v90, v91
v_max3_f32 v45, v45, v92, v93
v_max3_f32 v45, v45, v94, v95
v_max_f32 v46, v96, v97
v_max3_f32 v46, v46, v98, v99
v_max3_f32 v46, v46, v100, v101
v_max3_f32 v46, v46, v102, v103
v_max3_f32 v46, v46, v104, v105
v_max3_f32 v46, v46, v106, v107
v_max3_f32 v46, v46, v108, v109
v_max3_f32 v46, v46, v110, v111
v_mfma_f32_32x32x16_bf16 v[64:79], a[128:131], a[0:3], 0
v_mfma_f32_32x32x16_bf16 v[64:79], a[132:135], a[4:7], v[64:79]
v_mfma_f32_32x32x16_bf16 v[64:79], a[136:139], a[8:11], v[64:79]
v_mfma_f32_32x32x16_bf16 v[64:79], a[140:143], a[12:15], v[64:79]
v_mfma_f32_32x32x16_bf16 v[64:79], a[144:147], a[16:19], v[64:79]
v_mfma_f32_32x32x16_bf16 v[64:79], a[148:151], a[20:23], v[64:79]
v_mfma_f32_32x32x16_bf16 v[64:79], a[152:155], a[24:27], v[64:79]
v_mfma_f32_32x32x16_bf16 v[64:79], a[156:159], a[28:31], v[64:79]
v_mfma_f32_32x32x16_bf16 v[80:95], a[128:131], a[32:35], 0
v_mfma_f32_32x32x16_bf16 v[80:95], a[132:135], a[36:39], v[80:95]
v_mfma_f32_32x32x16_bf16 v[80:95], a[136:139], a[40:43], v[80:95]
v_mfma_f32_32x32x16_bf16 v[80:95], a[140:143], a[44:47], v[80:95]
v_mfma_f32_32x32x16_bf16 v[80:95], a[144:147], a[48:51], v[80:95]
v_mfma_f32_32x32x16_bf16 v[80:95], a[148:151], a[52:55], v[80:95]
v_mfma_f32_32x32x16_bf16 v[80:95], a[152:155], a[56:59], v[80:95]
v_mfma_f32_32x32x16_bf16 v[80:95], a[156:159], a[60:63], v[80:95]
v_mfma_f32_32x32x16_bf16 v[96:111], a[128:131], a[64:67], 0
v_mfma_f32_32x32x16_bf16 v[96:111], a[132:135], a[68:71], v[96:111]
v_mfma_f32_32x32x16_bf16 v[96:111], a[136:139], a[72:75], v[96:111]
v_mfma_f32_32x32x16_bf16 v[96:111], a[140:143], a[76:79], v[96:111]
v_mfma_f32_32x32x16_bf16 v[96:111], a[144:147], a[80:83], v[96:111]
v_mfma_f32_32x32x16_bf16 v[96:111], a[148:151], a[84:87], v[96:111]
v_mfma_f32_32x32x16_bf16 v[96:111], a[152:155], a[88:91], v[96:111]
v_mfma_f32_32x32x16_bf16 v[96:111], a[156:159], a[92:95], v[96:111]
v_max3_f32 v44, v44, v64, v65
v_max3_f32 v44, v44, v66, v67
v_max3_f32 v44, v44, v68, v69
v_max3_f32 v44, v44, v70, v71
v_max3_f32 v44, v44, v72, v73
v_max3_f32 v44, v44, v74, v75
v_max3_f32 v44, v44, v76, v77
v_max3_f32 v44, v44, v78, v79
v_max3_f32 v45, v45, v80, v81
v_max3_f32 v45, v45, v82, v83
v_max3_f32 v45, v45, v84, v85
v_max3_f32 v45, v45, v86, v87
v_max3_f32 v45, v45, v88, v89
v_max3_f32 v45, v45, v90, v91
v_max3_f32 v45, v45, v92, v93
v_max3_f32 v45, v45, v94, v95
v_max3_f32 v46, v46, v96, v97
v_max3_f32 v46, v46, v98, v99
v_max3_f32 v46, v46, v100, v101
v_max3_f32 v46, v46, v102, v103
v_max3_f32 v46, v46, v104, v105
v_max3_f32 v46, v46, v106, v107
v_max3_f32 v46, v46, v108, v109
v_max3_f32 v46, v46, v110, v111
v_mfma_f32_32x32x16_bf16 v[64:79], a[160:163], a[0:3], 0
v_mfma_f32_32x32x16_bf16 v[64:79], a[164:167], a[4:7], v[64:79]
v_mfma_f32_32x32x16_bf16 v[64:79], a[168:171], a[8:11], v[64:79]
v_mfma_f32_32x32x16_bf16 v[64:79], a[172:175], a[12:15], v[64:79]
v_mfma_f32_32x32x16_bf16 v[64:79], a[176:179], a[16:19], v[64:79]
v_mfma_f32_32x32x16_bf16 v[64:79], a[180:183], a[20:23], v[64:79]
v_mfma_f32_32x32x16_bf16 v[64:79], a[184:187], a[24:27], v[64:79]
v_mfma_f32_32x32x16_bf16 v[64:79], a[188:191], a[28:31], v[64:79]
v_mfma_f32_32x32x16_bf16 v[80:95], a[160:163], a[32:35], 0
v_mfma_f32_32x32x16_bf16 v[80:95], a[164:167], a[36:39], v[80:95]
v_mfma_f32_32x32x16_bf16 v[80:95], a[168:171], a[40:43], v[80:95]
v_mfma_f32_32x32x16_bf16 v[80:95], a[172:175], a[44:47], v[80:95]
v_mfma_f32_32x32x16_bf16 v[80:95], a[176:179], a[48:51], v[80:95]
v_mfma_f32_32x32x16_bf16 v[80:95], a[180:183], a[52:55], v[80:95]
v_mfma_f32_32x32x16_bf16 v[80:95], a[184:187], a[56:59], v[80:95]
v_mfma_f32_32x32x16_bf16 v[80:95], a[188:191], a[60:63], v[80:95]
v_mfma_f32_32x32x16_bf16 v[96:111], a[160:163], a[64:67], 0
v_mfma_f32_32x32x16_bf16 v[96:111], a[164:167], a[68:71], v[96:111]
v_mfma_f32_32x32x16_bf16 v[96:111], a[168:171], a[72:75], v[96:111]
v_mfma_f32_32x32x16_bf16 v[96:111], a[172:175], a[76:79], v[96:111]
v_mfma_f32_32x32x16_bf16 v[96:111], a[176:179], a[80:83], v[96:111]
v_mfma_f32_32x32x16_bf16 v[96:111], a[180:183], a[84:87], v[96:111]
v_mfma_f32_32x32x16_bf16 v[96:111], a[184:187], a[88:91], v[96:111]
v_mfma_f32_32x32x16_bf16 v[96:111], a[188:191], a[92:95], v[96:111]
v_max3_f32 v44, v44, v64, v65
v_max3_f32 v44, v44, v66, v67
v_max3_f32 v44, v44, v68, v69
v_max3_f32 v44, v44, v70, v71
v_max3_f32 v44, v44, v72, v73
v_max3_f32 v44, v44, v74, v75
v_max3_f32 v44, v44, v76, v77
v_max3_f32 v44, v44, v78, v79
v_max3_f32 v45, v45, v80, v81
v_max3_f32 v45, v45, v82, v83
v_max3_f32 v45, v45, v84, v85
v_max3_f32 v45, v45, v86, v87
v_max3_f32 v45, v45, v88, v89
v_max3_f32 v45, v45, v90, v91
v_max3_f32 v45, v45, v92, v93
v_max3_f32 v45, v45, v94, v95
v_max3_f32 v46, v46, v96, v97
v_max3_f32 v46, v46, v98, v99
v_max3_f32 v46, v46, v100, v101
v_max3_f32 v46, v46, v102, v103
v_max3_f32 v46, v46, v104, v105
v_max3_f32 v46, v46, v106, v107
v_max3_f32 v46, v46, v108, v109
v_max3_f32 v46, v46, v110, v111
v_mfma_f32_32x32x16_bf16 v[64:79], a[192:195], a[0:3], 0
v_mfma_f32_32x32x16_bf16 v[64:79], a[196:199], a[4:7], v[64:79]
v_mfma_f32_32x32x16_bf16 v[64:79], a[200:203], a[8:11], v[64:79]
v_mfma_f32_32x32x16_bf16 v[64:79], a[204:207], a[12:15], v[64:79]
v_mfma_f32_32x32x16_bf16 v[64:79], a[208:211], a[16:19], v[64:79]
v_mfma_f32_32x32x16_bf16 v[64:79], a[212:215], a[20:23], v[64:79]
v_mfma_f32_32x32x16_bf16 v[64:79], a[216:219], a[24:27], v[64:79]
v_mfma_f32_32x32x16_bf16 v[64:79], a[220:223], a[28:31], v[64:79]
v_mfma_f32_32x32x16_bf16 v[80:95], a[192:195], a[32:35], 0
v_mfma_f32_32x32x16_bf16 v[80:95], a[196:199], a[36:39], v[80:95]
v_mfma_f32_32x32x16_bf16 v[80:95], a[200:203], a[40:43], v[80:95]
v_mfma_f32_32x32x16_bf16 v[80:95], a[204:207], a[44:47], v[80:95]
v_mfma_f32_32x32x16_bf16 v[80:95], a[208:211], a[48:51], v[80:95]
v_mfma_f32_32x32x16_bf16 v[80:95], a[212:215], a[52:55], v[80:95]
v_mfma_f32_32x32x16_bf16 v[80:95], a[216:219], a[56:59], v[80:95]
v_mfma_f32_32x32x16_bf16 v[80:95], a[220:223], a[60:63], v[80:95]
v_mfma_f32_32x32x16_bf16 v[96:111], a[192:195], a[64:67], 0
v_mfma_f32_32x32x16_bf16 v[96:111], a[196:199], a[68:71], v[96:111]
v_mfma_f32_32x32x16_bf16 v[96:111], a[200:203], a[72:75], v[96:111]
v_mfma_f32_32x32x16_bf16 v[96:111], a[204:207], a[76:79], v[96:111]
v_mfma_f32_32x32x16_bf16 v[96:111], a[208:211], a[80:83], v[96:111]
v_mfma_f32_32x32x16_bf16 v[96:111], a[212:215], a[84:87], v[96:111]
v_mfma_f32_32x32x16_bf16 v[96:111], a[216:219], a[88:91], v[96:111]
v_mfma_f32_32x32x16_bf16 v[96:111], a[220:223], a[92:95], v[96:111]
v_max3_f32 v44, v44, v64, v65
v_max3_f32 v44, v44, v66, v67
v_max3_f32 v44, v44, v68, v69
v_max3_f32 v44, v44, v70, v71
v_max3_f32 v44, v44, v72, v73
v_max3_f32 v44, v44, v74, v75
v_max3_f32 v44, v44, v76, v77
v_max3_f32 v44, v44, v78, v79
v_max3_f32 v45, v45, v80, v81
v_max3_f32 v45, v45, v82, v83
v_max3_f32 v45, v45, v84, v85
v_max3_f32 v45, v45, v86, v87
v_max3_f32 v45, v45, v88, v89
v_max3_f32 v45, v45, v90, v91
v_max3_f32 v45, v45, v92, v93
v_max3_f32 v45, v45, v94, v95
v_max3_f32 v46, v46, v96, v97
v_max3_f32 v46, v46, v98, v99
v_max3_f32 v46, v46, v100, v101
v_max3_f32 v46, v46, v102, v103
v_max3_f32 v46, v46, v104, v105
v_max3_f32 v46, v46, v106, v107
v_max3_f32 v46, v46, v108, v109
v_max3_f32 v46, v46, v110, v111
v_mov_b32 v48, v44
v_mov_b32 v49, v45
v_mov_b32 v50, v46
v_permlane32_swap_b32 v48, v44
v_permlane32_swap_b32 v49, v45
v_permlane32_swap_b32 v50, v46
v_max_f32 v44, v44, v48
v_max_f32 v45, v45, v49
v_max_f32 v46, v46, v50
ds_write_b128 v27, v[44:47] offset:39936
s_waitcnt lgkmcnt(0)
s_barrier
ds_read_b128 v[48:51], v26 offset:39936
ds_read_b128 v[52:55], v26 offset:48128
ds_read_b128 v[56:59], v26 offset:56320
ds_read_b128 v[60:63], v26 offset:64512
s_waitcnt lgkmcnt(1)
v_max3_f32 v44, v48, v52, v56
s_waitcnt lgkmcnt(0)
v_max_f32 v44, v44, v60
v_max3_f32 v45, v49, v53, v57
v_max_f32 v45, v45, v61
v_max3_f32 v46, v50, v54, v58
v_max_f32 v46, v46, v62
v_mfma_f32_32x32x16_bf16 v[64:79], a[96:99], a[0:3], 0
v_mfma_f32_32x32x16_bf16 v[64:79], a[100:103], a[4:7], v[64:79]
v_mfma_f32_32x32x16_bf16 v[64:79], a[104:107], a[8:11], v[64:79]
v_mfma_f32_32x32x16_bf16 v[64:79], a[108:111], a[12:15], v[64:79]
v_mfma_f32_32x32x16_bf16 v[64:79], a[112:115], a[16:19], v[64:79]
v_mfma_f32_32x32x16_bf16 v[64:79], a[116:119], a[20:23], v[64:79]
v_mfma_f32_32x32x16_bf16 v[64:79], a[120:123], a[24:27], v[64:79]
v_mfma_f32_32x32x16_bf16 v[64:79], a[124:127], a[28:31], v[64:79]
v_mfma_f32_32x32x16_bf16 v[80:95], a[96:99], a[32:35], 0
v_mfma_f32_32x32x16_bf16 v[80:95], a[100:103], a[36:39], v[80:95]
s_nop 9
v_sub_f32 v64, v64, v44
v_exp_f32 v64, v64
v_sub_f32 v65, v65, v44
v_exp_f32 v65, v65
v_sub_f32 v66, v66, v44
v_mfma_f32_32x32x16_bf16 v[80:95], a[104:107], a[40:43], v[80:95]
v_exp_f32 v66, v66
v_sub_f32 v67, v67, v44
v_exp_f32 v67, v67
v_add_f32 v40, v64, v65
v_cvt_pk_bf16_f32 v64, v64, v65
v_sub_f32 v68, v68, v44
v_mfma_f32_32x32x16_bf16 v[80:95], a[108:111], a[44:47], v[80:95]
v_exp_f32 v68, v68
v_sub_f32 v69, v69, v44
v_exp_f32 v69, v69
v_add_f32 v40, v40, v66
v_add_f32 v40, v40, v67
v_mfma_f32_32x32x16_bf16 v[80:95], a[112:115], a[48:51], v[80:95]
v_cvt_pk_bf16_f32 v65, v66, v67
v_sub_f32 v70, v70, v44
v_exp_f32 v70, v70
v_sub_f32 v71, v71, v44
v_exp_f32 v71, v71
v_add_f32 v40, v40, v68
v_mfma_f32_32x32x16_bf16 v[80:95], a[116:119], a[52:55], v[80:95]
v_add_f32 v40, v40, v69
v_cvt_pk_bf16_f32 v66, v68, v69
v_add_f32 v40, v40, v70
v_add_f32 v40, v40, v71
v_cvt_pk_bf16_f32 v67, v70, v71
v_sub_f32 v72, v72, v44
v_mfma_f32_32x32x16_bf16 v[80:95], a[120:123], a[56:59], v[80:95]
ds_write_b128 v27, v[64:67] offset:0
v_exp_f32 v72, v72
v_sub_f32 v73, v73, v44
v_mfma_f32_32x32x16_bf16 v[80:95], a[124:127], a[60:63], v[80:95]
v_exp_f32 v73, v73
v_sub_f32 v74, v74, v44
v_exp_f32 v74, v74
v_sub_f32 v75, v75, v44
v_exp_f32 v75, v75
v_mfma_f32_32x32x16_bf16 v[96:111], a[96:99], a[64:67], 0
v_add_f32 v40, v40, v72
v_add_f32 v40, v40, v73
v_cvt_pk_bf16_f32 v68, v72, v73
v_sub_f32 v76, v76, v44
v_exp_f32 v76, v76
v_sub_f32 v77, v77, v44
v_mfma_f32_32x32x16_bf16 v[96:111], a[100:103], a[68:71], v[96:111]
v_exp_f32 v77, v77
v_add_f32 v40, v40, v74
v_add_f32 v40, v40, v75
v_cvt_pk_bf16_f32 v69, v74, v75
v_sub_f32 v78, v78, v44
v_exp_f32 v78, v78
v_mfma_f32_32x32x16_bf16 v[96:111], a[104:107], a[72:75], v[96:111]
v_sub_f32 v79, v79, v44
v_exp_f32 v79, v79
v_add_f32 v40, v40, v76
v_add_f32 v40, v40, v77
v_cvt_pk_bf16_f32 v70, v76, v77
v_add_f32 v40, v40, v78
v_mfma_f32_32x32x16_bf16 v[96:111], a[108:111], a[76:79], v[96:111]
v_add_f32 v40, v40, v79
v_cvt_pk_bf16_f32 v71, v78, v79
v_sub_f32 v80, v80, v45
v_exp_f32 v80, v80
v_sub_f32 v81, v81, v45
v_exp_f32 v81, v81
v_mfma_f32_32x32x16_bf16 v[96:111], a[112:115], a[80:83], v[96:111]
ds_write_b128 v27, v[68:71] offset:3072
v_sub_f32 v82, v82, v45
v_mfma_f32_32x32x16_bf16 v[96:111], a[116:119], a[84:87], v[96:111]
v_exp_f32 v82, v82
v_sub_f32 v83, v83, v45
v_exp_f32 v83, v83
v_add_f32 v41, v80, v81
v_cvt_pk_bf16_f32 v80, v80, v81
v_sub_f32 v84, v84, v45
v_mfma_f32_32x32x16_bf16 v[96:111], a[120:123], a[88:91], v[96:111]
v_exp_f32 v84, v84
v_sub_f32 v85, v85, v45
v_exp_f32 v85, v85
v_add_f32 v41, v41, v82
v_add_f32 v41, v41, v83
v_cvt_pk_bf16_f32 v81, v82, v83
v_mfma_f32_32x32x16_bf16 v[96:111], a[124:127], a[92:95], v[96:111]
v_sub_f32 v86, v86, v45
v_exp_f32 v86, v86
v_sub_f32 v87, v87, v45
v_exp_f32 v87, v87
v_add_f32 v41, v41, v84
v_add_f32 v41, v41, v85
v_mfma_f32_32x32x16_bf16 v[112:127], a[128:131], a[0:3], 0
v_cvt_pk_bf16_f32 v82, v84, v85
v_add_f32 v41, v41, v86
v_add_f32 v41, v41, v87
v_cvt_pk_bf16_f32 v83, v86, v87
v_sub_f32 v88, v88, v45
v_exp_f32 v88, v88
v_mfma_f32_32x32x16_bf16 v[112:127], a[132:135], a[4:7], v[112:127]
ds_write_b128 v27, v[80:83] offset:1024
v_sub_f32 v89, v89, v45
v_mfma_f32_32x32x16_bf16 v[112:127], a[136:139], a[8:11], v[112:127]
v_exp_f32 v89, v89
v_sub_f32 v90, v90, v45
v_exp_f32 v90, v90
v_sub_f32 v91, v91, v45
v_exp_f32 v91, v91
v_add_f32 v41, v41, v88
v_mfma_f32_32x32x16_bf16 v[112:127], a[140:143], a[12:15], v[112:127]
v_add_f32 v41, v41, v89
v_cvt_pk_bf16_f32 v84, v88, v89
v_sub_f32 v92, v92, v45
v_exp_f32 v92, v92
v_sub_f32 v93, v93, v45
v_mfma_f32_32x32x16_bf16 v[112:127], a[144:147], a[16:19], v[112:127]
v_exp_f32 v93, v93
v_add_f32 v41, v41, v90
v_add_f32 v41, v41, v91
v_cvt_pk_bf16_f32 v85, v90, v91
v_sub_f32 v94, v94, v45
v_exp_f32 v94, v94
v_sub_f32 v95, v95, v45
v_mfma_f32_32x32x16_bf16 v[112:127], a[148:151], a[20:23], v[112:127]
v_exp_f32 v95, v95
v_add_f32 v41, v41, v92
v_add_f32 v41, v41, v93
v_cvt_pk_bf16_f32 v86, v92, v93
v_add_f32 v41, v41, v94
v_add_f32 v41, v41, v95
v_mfma_f32_32x32x16_bf16 v[112:127], a[152:155], a[24:27], v[112:127]
v_cvt_pk_bf16_f32 v87, v94, v95
v_sub_f32 v96, v96, v46
v_exp_f32 v96, v96
v_sub_f32 v97, v97, v46
v_exp_f32 v97, v97
v_sub_f32 v98, v98, v46
v_mfma_f32_32x32x16_bf16 v[112:127], a[156:159], a[28:31], v[112:127]
ds_write_b128 v27, v[84:87] offset:4096
v_exp_f32 v98, v98
v_mfma_f32_32x32x16_bf16 v[128:143], a[128:131], a[32:35], 0
v_sub_f32 v99, v99, v46
v_exp_f32 v99, v99
v_add_f32 v42, v96, v97
v_cvt_pk_bf16_f32 v96, v96, v97
v_sub_f32 v100, v100, v46
v_exp_f32 v100, v100
v_mfma_f32_32x32x16_bf16 v[128:143], a[132:135], a[36:39], v[128:143]
v_sub_f32 v101, v101, v46
v_exp_f32 v101, v101
v_add_f32 v42, v42, v98
v_add_f32 v42, v42, v99
v_cvt_pk_bf16_f32 v97, v98, v99
v_sub_f32 v102, v102, v46
v_mfma_f32_32x32x16_bf16 v[128:143], a[136:139], a[40:43], v[128:143]
v_exp_f32 v102, v102
v_sub_f32 v103, v103, v46
v_exp_f32 v103, v103
v_add_f32 v42, v42, v100
v_add_f32 v42, v42, v101
v_cvt_pk_bf16_f32 v98, v100, v101
v_mfma_f32_32x32x16_bf16 v[128:143], a[140:143], a[44:47], v[128:143]
v_add_f32 v42, v42, v102
v_add_f32 v42, v42, v103
v_cvt_pk_bf16_f32 v99, v102, v103
v_sub_f32 v104, v104, v46
v_exp_f32 v104, v104
v_sub_f32 v105, v105, v46
v_mfma_f32_32x32x16_bf16 v[128:143], a[144:147], a[48:51], v[128:143]
ds_write_b128 v27, v[96:99] offset:2048
v_exp_f32 v105, v105
v_mfma_f32_32x32x16_bf16 v[128:143], a[148:151], a[52:55], v[128:143]
v_sub_f32 v106, v106, v46
v_exp_f32 v106, v106
v_sub_f32 v107, v107, v46
v_exp_f32 v107, v107
v_add_f32 v42, v42, v104
v_add_f32 v42, v42, v105
v_mfma_f32_32x32x16_bf16 v[128:143], a[152:155], a[56:59], v[128:143]
v_cvt_pk_bf16_f32 v100, v104, v105
v_sub_f32 v108, v108, v46
v_exp_f32 v108, v108
v_sub_f32 v109, v109, v46
v_exp_f32 v109, v109
v_mfma_f32_32x32x16_bf16 v[128:143], a[156:159], a[60:63], v[128:143]
v_add_f32 v42, v42, v106
v_add_f32 v42, v42, v107
v_cvt_pk_bf16_f32 v101, v106, v107
v_sub_f32 v110, v110, v46
v_exp_f32 v110, v110
v_sub_f32 v111, v111, v46
v_mfma_f32_32x32x16_bf16 v[144:159], a[128:131], a[64:67], 0
v_exp_f32 v111, v111
v_add_f32 v42, v42, v108
v_add_f32 v42, v42, v109
v_cvt_pk_bf16_f32 v102, v108, v109
v_add_f32 v42, v42, v110
v_add_f32 v42, v42, v111
v_cvt_pk_bf16_f32 v103, v110, v111
v_mfma_f32_32x32x16_bf16 v[144:159], a[132:135], a[68:71], v[144:159]
ds_write_b128 v27, v[100:103] offset:5120
v_sub_f32 v112, v112, v44
v_exp_f32 v112, v112
v_mfma_f32_32x32x16_bf16 v[144:159], a[136:139], a[72:75], v[144:159]
v_sub_f32 v113, v113, v44
v_exp_f32 v113, v113
v_sub_f32 v114, v114, v44
v_exp_f32 v114, v114
v_sub_f32 v115, v115, v44
v_mfma_f32_32x32x16_bf16 v[144:159], a[140:143], a[76:79], v[144:159]
v_exp_f32 v115, v115
v_add_f32 v40, v40, v112
v_add_f32 v40, v40, v113
v_cvt_pk_bf16_f32 v112, v112, v113
v_sub_f32 v116, v116, v44
v_exp_f32 v116, v116
v_mfma_f32_32x32x16_bf16 v[144:159], a[144:147], a[80:83], v[144:159]
v_sub_f32 v117, v117, v44
v_exp_f32 v117, v117
v_add_f32 v40, v40, v114
v_add_f32 v40, v40, v115
v_cvt_pk_bf16_f32 v113, v114, v115
v_sub_f32 v118, v118, v44
v_mfma_f32_32x32x16_bf16 v[144:159], a[148:151], a[84:87], v[144:159]
v_exp_f32 v118, v118
v_sub_f32 v119, v119, v44
v_exp_f32 v119, v119
v_add_f32 v40, v40, v116
v_add_f32 v40, v40, v117
v_cvt_pk_bf16_f32 v114, v116, v117
v_mfma_f32_32x32x16_bf16 v[144:159], a[152:155], a[88:91], v[144:159]
v_add_f32 v40, v40, v118
v_add_f32 v40, v40, v119
v_cvt_pk_bf16_f32 v115, v118, v119
v_sub_f32 v120, v120, v44
v_exp_f32 v120, v120
v_sub_f32 v121, v121, v44
v_mfma_f32_32x32x16_bf16 v[144:159], a[156:159], a[92:95], v[144:159]
ds_write_b128 v27, v[112:115] offset:32768
v_exp_f32 v121, v121
v_mfma_f32_32x32x16_bf16 v[160:175], a[160:163], a[0:3], 0
v_sub_f32 v122, v122, v44
v_exp_f32 v122, v122
v_sub_f32 v123, v123, v44
v_exp_f32 v123, v123
v_add_f32 v40, v40, v120
v_add_f32 v40, v40, v121
v_mfma_f32_32x32x16_bf16 v[160:175], a[164:167], a[4:7], v[160:175]
v_cvt_pk_bf16_f32 v116, v120, v121
v_sub_f32 v124, v124, v44
v_exp_f32 v124, v124
v_sub_f32 v125, v125, v44
v_exp_f32 v125, v125
v_mfma_f32_32x32x16_bf16 v[160:175], a[168:171], a[8:11], v[160:175]
v_add_f32 v40, v40, v122
v_add_f32 v40, v40, v123
v_cvt_pk_bf16_f32 v117, v122, v123
v_sub_f32 v126, v126, v44
v_exp_f32 v126, v126
v_sub_f32 v127, v127, v44
v_mfma_f32_32x32x16_bf16 v[160:175], a[172:175], a[12:15], v[160:175]
v_exp_f32 v127, v127
v_add_f32 v40, v40, v124
v_add_f32 v40, v40, v125
v_cvt_pk_bf16_f32 v118, v124, v125
v_add_f32 v40, v40, v126
v_add_f32 v40, v40, v127
v_cvt_pk_bf16_f32 v119, v126, v127
v_mfma_f32_32x32x16_bf16 v[160:175], a[176:179], a[16:19], v[160:175]
ds_write_b128 v27, v[116:119] offset:35840
v_sub_f32 v128, v128, v45
v_exp_f32 v128, v128
v_mfma_f32_32x32x16_bf16 v[160:175], a[180:183], a[20:23], v[160:175]
v_sub_f32 v129, v129, v45
v_exp_f32 v129, v129
v_sub_f32 v130, v130, v45
v_exp_f32 v130, v130
v_sub_f32 v131, v131, v45
v_mfma_f32_32x32x16_bf16 v[160:175], a[184:187], a[24:27], v[160:175]
v_exp_f32 v131, v131
v_add_f32 v41, v41, v128
v_add_f32 v41, v41, v129
v_cvt_pk_bf16_f32 v128, v128, v129
v_sub_f32 v132, v132, v45
v_exp_f32 v132, v132
v_mfma_f32_32x32x16_bf16 v[160:175], a[188:191], a[28:31], v[160:175]
v_sub_f32 v133, v133, v45
v_exp_f32 v133, v133
v_add_f32 v41, v41, v130
v_add_f32 v41, v41, v131
v_cvt_pk_bf16_f32 v129, v130, v131
v_sub_f32 v134, v134, v45
v_mfma_f32_32x32x16_bf16 v[176:191], a[160:163], a[32:35], 0
v_exp_f32 v134, v134
v_sub_f32 v135, v135, v45
v_exp_f32 v135, v135
v_add_f32 v41, v41, v132
v_add_f32 v41, v41, v133
v_cvt_pk_bf16_f32 v130, v132, v133
v_mfma_f32_32x32x16_bf16 v[176:191], a[164:167], a[36:39], v[176:191]
v_add_f32 v41, v41, v134
v_add_f32 v41, v41, v135
v_cvt_pk_bf16_f32 v131, v134, v135
v_sub_f32 v136, v136, v45
v_exp_f32 v136, v136
v_sub_f32 v137, v137, v45
v_mfma_f32_32x32x16_bf16 v[176:191], a[168:171], a[40:43], v[176:191]
ds_write_b128 v27, v[128:131] offset:33792
v_exp_f32 v137, v137
v_mfma_f32_32x32x16_bf16 v[176:191], a[172:175], a[44:47], v[176:191]
v_sub_f32 v138, v138, v45
v_exp_f32 v138, v138
v_sub_f32 v139, v139, v45
v_exp_f32 v139, v139
v_add_f32 v41, v41, v136
v_add_f32 v41, v41, v137
v_mfma_f32_32x32x16_bf16 v[176:191], a[176:179], a[48:51], v[176:191]
v_cvt_pk_bf16_f32 v132, v136, v137
v_sub_f32 v140, v140, v45
v_exp_f32 v140, v140
v_sub_f32 v141, v141, v45
v_exp_f32 v141, v141
v_mfma_f32_32x32x16_bf16 v[176:191], a[180:183], a[52:55], v[176:191]
v_add_f32 v41, v41, v138
v_add_f32 v41, v41, v139
v_cvt_pk_bf16_f32 v133, v138, v139
v_sub_f32 v142, v142, v45
v_exp_f32 v142, v142
v_sub_f32 v143, v143, v45
v_mfma_f32_32x32x16_bf16 v[176:191], a[184:187], a[56:59], v[176:191]
v_exp_f32 v143, v143
v_add_f32 v41, v41, v140
v_add_f32 v41, v41, v141
v_cvt_pk_bf16_f32 v134, v140, v141
v_add_f32 v41, v41, v142
v_add_f32 v41, v41, v143
v_cvt_pk_bf16_f32 v135, v142, v143
v_mfma_f32_32x32x16_bf16 v[176:191], a[188:191], a[60:63], v[176:191]
ds_write_b128 v27, v[132:135] offset:36864
v_sub_f32 v144, v144, v46
v_exp_f32 v144, v144
v_mfma_f32_32x32x16_bf16 v[192:207], a[160:163], a[64:67], 0
v_sub_f32 v145, v145, v46
v_exp_f32 v145, v145
v_sub_f32 v146, v146, v46
v_exp_f32 v146, v146
v_sub_f32 v147, v147, v46
v_mfma_f32_32x32x16_bf16 v[192:207], a[164:167], a[68:71], v[192:207]
v_exp_f32 v147, v147
v_add_f32 v42, v42, v144
v_add_f32 v42, v42, v145
v_cvt_pk_bf16_f32 v144, v144, v145
v_sub_f32 v148, v148, v46
v_exp_f32 v148, v148
v_mfma_f32_32x32x16_bf16 v[192:207], a[168:171], a[72:75], v[192:207]
v_sub_f32 v149, v149, v46
v_exp_f32 v149, v149
v_add_f32 v42, v42, v146
v_add_f32 v42, v42, v147
v_cvt_pk_bf16_f32 v145, v146, v147
v_sub_f32 v150, v150, v46
v_mfma_f32_32x32x16_bf16 v[192:207], a[172:175], a[76:79], v[192:207]
v_exp_f32 v150, v150
v_sub_f32 v151, v151, v46
v_exp_f32 v151, v151
v_add_f32 v42, v42, v148
v_add_f32 v42, v42, v149
v_cvt_pk_bf16_f32 v146, v148, v149
v_mfma_f32_32x32x16_bf16 v[192:207], a[176:179], a[80:83], v[192:207]
v_add_f32 v42, v42, v150
v_add_f32 v42, v42, v151
v_cvt_pk_bf16_f32 v147, v150, v151
v_sub_f32 v152, v152, v46
v_exp_f32 v152, v152
v_sub_f32 v153, v153, v46
v_mfma_f32_32x32x16_bf16 v[192:207], a[180:183], a[84:87], v[192:207]
ds_write_b128 v27, v[144:147] offset:34816
v_exp_f32 v153, v153
v_mfma_f32_32x32x16_bf16 v[192:207], a[184:187], a[88:91], v[192:207]
v_sub_f32 v154, v154, v46
v_exp_f32 v154, v154
v_sub_f32 v155, v155, v46
v_exp_f32 v155, v155
v_add_f32 v42, v42, v152
v_add_f32 v42, v42, v153
v_mfma_f32_32x32x16_bf16 v[192:207], a[188:191], a[92:95], v[192:207]
v_cvt_pk_bf16_f32 v148, v152, v153
v_sub_f32 v156, v156, v46
v_exp_f32 v156, v156
v_sub_f32 v157, v157, v46
v_exp_f32 v157, v157
v_mfma_f32_32x32x16_bf16 v[64:79], a[192:195], a[0:3], 0
v_add_f32 v42, v42, v154
v_add_f32 v42, v42, v155
v_cvt_pk_bf16_f32 v149, v154, v155
v_sub_f32 v158, v158, v46
v_exp_f32 v158, v158
v_sub_f32 v159, v159, v46
v_mfma_f32_32x32x16_bf16 v[64:79], a[196:199], a[4:7], v[64:79]
v_exp_f32 v159, v159
v_add_f32 v42, v42, v156
v_add_f32 v42, v42, v157
v_cvt_pk_bf16_f32 v150, v156, v157
v_add_f32 v42, v42, v158
v_add_f32 v42, v42, v159
v_cvt_pk_bf16_f32 v151, v158, v159
v_mfma_f32_32x32x16_bf16 v[64:79], a[200:203], a[8:11], v[64:79]
ds_write_b128 v27, v[148:151] offset:37888
v_sub_f32 v160, v160, v44
v_exp_f32 v160, v160
v_mfma_f32_32x32x16_bf16 v[64:79], a[204:207], a[12:15], v[64:79]
v_sub_f32 v161, v161, v44
v_exp_f32 v161, v161
v_sub_f32 v162, v162, v44
v_exp_f32 v162, v162
v_sub_f32 v163, v163, v44
v_mfma_f32_32x32x16_bf16 v[64:79], a[208:211], a[16:19], v[64:79]
v_exp_f32 v163, v163
v_add_f32 v40, v40, v160
v_add_f32 v40, v40, v161
v_cvt_pk_bf16_f32 v160, v160, v161
v_sub_f32 v164, v164, v44
v_exp_f32 v164, v164
v_mfma_f32_32x32x16_bf16 v[64:79], a[212:215], a[20:23], v[64:79]
v_sub_f32 v165, v165, v44
v_exp_f32 v165, v165
v_add_f32 v40, v40, v162
v_add_f32 v40, v40, v163
v_cvt_pk_bf16_f32 v161, v162, v163
v_sub_f32 v166, v166, v44
v_mfma_f32_32x32x16_bf16 v[64:79], a[216:219], a[24:27], v[64:79]
v_exp_f32 v166, v166
v_sub_f32 v167, v167, v44
v_exp_f32 v167, v167
v_add_f32 v40, v40, v164
v_add_f32 v40, v40, v165
v_cvt_pk_bf16_f32 v162, v164, v165
v_mfma_f32_32x32x16_bf16 v[64:79], a[220:223], a[28:31], v[64:79]
v_add_f32 v40, v40, v166
v_add_f32 v40, v40, v167
v_cvt_pk_bf16_f32 v163, v166, v167
v_sub_f32 v168, v168, v44
v_exp_f32 v168, v168
v_sub_f32 v169, v169, v44
v_mfma_f32_32x32x16_bf16 v[80:95], a[192:195], a[32:35], 0
v_exp_f32 v169, v169
v_sub_f32 v170, v170, v44
v_exp_f32 v170, v170
v_sub_f32 v171, v171, v44
v_exp_f32 v171, v171
v_mfma_f32_32x32x16_bf16 v[80:95], a[196:199], a[36:39], v[80:95]
v_add_f32 v40, v40, v168
v_add_f32 v40, v40, v169
v_cvt_pk_bf16_f32 v164, v168, v169
v_sub_f32 v172, v172, v44
v_exp_f32 v172, v172
v_sub_f32 v173, v173, v44
v_mfma_f32_32x32x16_bf16 v[80:95], a[200:203], a[40:43], v[80:95]
v_exp_f32 v173, v173
v_add_f32 v40, v40, v170
v_add_f32 v40, v40, v171
v_cvt_pk_bf16_f32 v165, v170, v171
v_sub_f32 v174, v174, v44
v_exp_f32 v174, v174
v_mfma_f32_32x32x16_bf16 v[80:95], a[204:207], a[44:47], v[80:95]
v_sub_f32 v175, v175, v44
v_exp_f32 v175, v175
v_add_f32 v40, v40, v172
v_add_f32 v40, v40, v173
v_cvt_pk_bf16_f32 v166, v172, v173
v_add_f32 v40, v40, v174
v_mfma_f32_32x32x16_bf16 v[80:95], a[208:211], a[48:51], v[80:95]
v_add_f32 v40, v40, v175
v_cvt_pk_bf16_f32 v167, v174, v175
v_sub_f32 v176, v176, v45
v_exp_f32 v176, v176
v_sub_f32 v177, v177, v45
v_exp_f32 v177, v177
v_mfma_f32_32x32x16_bf16 v[80:95], a[212:215], a[52:55], v[80:95]
v_sub_f32 v178, v178, v45
v_exp_f32 v178, v178
v_sub_f32 v179, v179, v45
v_exp_f32 v179, v179
v_add_f32 v41, v41, v176
v_mfma_f32_32x32x16_bf16 v[80:95], a[216:219], a[56:59], v[80:95]
v_add_f32 v41, v41, v177
v_cvt_pk_bf16_f32 v176, v176, v177
v_sub_f32 v180, v180, v45
v_exp_f32 v180, v180
v_sub_f32 v181, v181, v45
v_exp_f32 v181, v181
v_mfma_f32_32x32x16_bf16 v[80:95], a[220:223], a[60:63], v[80:95]
v_add_f32 v41, v41, v178
v_add_f32 v41, v41, v179
v_cvt_pk_bf16_f32 v177, v178, v179
v_sub_f32 v182, v182, v45
v_exp_f32 v182, v182
v_sub_f32 v183, v183, v45
v_mfma_f32_32x32x16_bf16 v[96:111], a[192:195], a[64:67], 0
v_exp_f32 v183, v183
v_add_f32 v41, v41, v180
v_add_f32 v41, v41, v181
v_cvt_pk_bf16_f32 v178, v180, v181
v_add_f32 v41, v41, v182
v_add_f32 v41, v41, v183
v_cvt_pk_bf16_f32 v179, v182, v183
v_mfma_f32_32x32x16_bf16 v[96:111], a[196:199], a[68:71], v[96:111]
v_sub_f32 v184, v184, v45
v_exp_f32 v184, v184
v_sub_f32 v185, v185, v45
v_exp_f32 v185, v185
v_sub_f32 v186, v186, v45
v_mfma_f32_32x32x16_bf16 v[96:111], a[200:203], a[72:75], v[96:111]
v_exp_f32 v186, v186
v_sub_f32 v187, v187, v45
v_exp_f32 v187, v187
v_add_f32 v41, v41, v184
v_add_f32 v41, v41, v185
v_cvt_pk_bf16_f32 v180, v184, v185
v_mfma_f32_32x32x16_bf16 v[96:111], a[204:207], a[76:79], v[96:111]
s_waitcnt lgkmcnt(0)
s_barrier
v_mfma_f32_32x32x16_bf16 v[96:111], a[208:211], a[80:83], v[96:111]
ds_read_b64_tr_b16 a[224:225], v31 offset:32768
ds_read_b64_tr_b16 a[226:227], v31 offset:34816
ds_read_b128 a[228:231], v27 offset:0
v_sub_f32 v188, v188, v45
v_exp_f32 v188, v188
v_sub_f32 v189, v189, v45
v_mfma_f32_32x32x16_bf16 v[96:111], a[212:215], a[84:87], v[96:111]
ds_read_b128 a[232:235], v27 offset:1024
ds_read_b128 a[236:239], v27 offset:2048
v_exp_f32 v189, v189
v_add_f32 v41, v41, v186
v_add_f32 v41, v41, v187
v_cvt_pk_bf16_f32 v181, v186, v187
v_sub_f32 v190, v190, v45
v_mfma_f32_32x32x16_bf16 v[96:111], a[216:219], a[88:91], v[96:111]
ds_read_b64_tr_b16 a[240:241], v31 offset:36864
ds_read_b64_tr_b16 a[242:243], v31 offset:38912
ds_read_b128 a[244:247], v27 offset:3072
v_exp_f32 v190, v190
v_sub_f32 v191, v191, v45
v_mfma_f32_32x32x16_bf16 v[96:111], a[220:223], a[92:95], v[96:111]
s_waitcnt lgkmcnt(5)
ds_read_b128 a[248:251], v27 offset:4096
ds_read_b128 a[252:255], v27 offset:5120
v_exp_f32 v191, v191
v_add_f32 v41, v41, v188
v_add_f32 v41, v41, v189
v_cvt_pk_bf16_f32 v182, v188, v189
v_add_f32 v41, v41, v190
v_add_f32 v41, v41, v191
v_mfma_f32_32x32x16_bf16 v[208:223], a[224:227], a[228:231], 0
s_waitcnt lgkmcnt(6)
ds_read_b64_tr_b16 a[96:97], v32 offset:32768
ds_read_b64_tr_b16 a[98:99], v32 offset:34816
ds_read_b128 a[100:103], v28 offset:0
v_cvt_pk_bf16_f32 v183, v190, v191
v_sub_f32 v192, v192, v46
v_exp_f32 v192, v192
v_mfma_f32_32x32x16_bf16 v[224:239], a[224:227], a[232:235], 0
s_waitcnt lgkmcnt(8)
ds_read_b128 a[104:107], v28 offset:1024
ds_read_b128 a[108:111], v28 offset:2048
v_sub_f32 v193, v193, v46
v_exp_f32 v193, v193
v_sub_f32 v194, v194, v46
v_exp_f32 v194, v194
v_mfma_f32_32x32x16_bf16 v[240:255], a[224:227], a[236:239], 0
s_waitcnt lgkmcnt(7)
ds_read_b64_tr_b16 a[112:113], v32 offset:36864
ds_read_b64_tr_b16 a[114:115], v32 offset:38912
ds_read_b128 a[116:119], v28 offset:3072
v_sub_f32 v195, v195, v46
v_exp_f32 v195, v195
v_add_f32 v42, v42, v192
v_mfma_f32_32x32x16_bf16 v[208:223], a[240:243], a[244:247], v[208:223]
s_waitcnt lgkmcnt(9)
ds_read_b128 a[120:123], v28 offset:4096
ds_read_b128 a[124:127], v28 offset:5120
v_add_f32 v42, v42, v193
v_cvt_pk_bf16_f32 v192, v192, v193
v_sub_f32 v196, v196, v46
v_exp_f32 v196, v196
v_sub_f32 v197, v197, v46
v_mfma_f32_32x32x16_bf16 v[224:239], a[240:243], a[248:251], v[224:239]
s_waitcnt lgkmcnt(10)
ds_read_b64_tr_b16 a[128:129], v33 offset:32768
ds_read_b64_tr_b16 a[130:131], v33 offset:34816
ds_read_b128 a[132:135], v29 offset:0
v_exp_f32 v197, v197
v_add_f32 v42, v42, v194
v_add_f32 v42, v42, v195
v_mfma_f32_32x32x16_bf16 v[240:255], a[240:243], a[252:255], v[240:255]
s_waitcnt lgkmcnt(10)
ds_read_b128 a[136:139], v29 offset:1024
ds_read_b128 a[140:143], v29 offset:2048
v_cvt_pk_bf16_f32 v193, v194, v195
v_sub_f32 v198, v198, v46
v_exp_f32 v198, v198
v_sub_f32 v199, v199, v46
v_mfma_f32_32x32x16_bf16 v[208:223], a[96:99], a[100:103], v[208:223]
s_waitcnt lgkmcnt(11)
ds_read_b64_tr_b16 a[144:145], v33 offset:36864
ds_read_b64_tr_b16 a[146:147], v33 offset:38912
ds_read_b128 a[148:151], v29 offset:3072
v_exp_f32 v199, v199
v_add_f32 v42, v42, v196
v_add_f32 v42, v42, v197
v_cvt_pk_bf16_f32 v194, v196, v197
v_mfma_f32_32x32x16_bf16 v[224:239], a[96:99], a[104:107], v[224:239]
s_waitcnt lgkmcnt(13)
ds_read_b128 a[152:155], v29 offset:4096
ds_read_b128 a[156:159], v29 offset:5120
v_add_f32 v42, v42, v198
v_add_f32 v42, v42, v199
v_cvt_pk_bf16_f32 v195, v198, v199
v_sub_f32 v200, v200, v46
v_exp_f32 v200, v200
v_mfma_f32_32x32x16_bf16 v[240:255], a[96:99], a[108:111], v[240:255]
s_waitcnt lgkmcnt(12)
ds_read_b64_tr_b16 a[160:161], v34 offset:32768
ds_read_b64_tr_b16 a[162:163], v34 offset:34816
ds_read_b128 a[164:167], v30 offset:0
v_sub_f32 v201, v201, v46
v_exp_f32 v201, v201
v_sub_f32 v202, v202, v46
v_mfma_f32_32x32x16_bf16 v[208:223], a[112:115], a[116:119], v[208:223]
s_waitcnt lgkmcnt(14)
ds_read_b128 a[168:171], v30 offset:1024
ds_read_b128 a[172:175], v30 offset:2048
v_exp_f32 v202, v202
v_sub_f32 v203, v203, v46
v_exp_f32 v203, v203
v_add_f32 v42, v42, v200
v_mfma_f32_32x32x16_bf16 v[224:239], a[112:115], a[120:123], v[224:239]
s_waitcnt lgkmcnt(15)
ds_read_b64_tr_b16 a[176:177], v34 offset:36864
ds_read_b64_tr_b16 a[178:179], v34 offset:38912
ds_read_b128 a[180:183], v30 offset:3072
v_add_f32 v42, v42, v201
v_cvt_pk_bf16_f32 v196, v200, v201
v_sub_f32 v204, v204, v46
v_mfma_f32_32x32x16_bf16 v[240:255], a[112:115], a[124:127], v[240:255]
s_waitcnt lgkmcnt(15)
ds_read_b128 a[184:187], v30 offset:4096
ds_read_b128 a[188:191], v30 offset:5120
v_exp_f32 v204, v204
v_sub_f32 v205, v205, v46
v_exp_f32 v205, v205
v_add_f32 v42, v42, v202
v_add_f32 v42, v42, v203
v_mfma_f32_32x32x16_bf16 v[208:223], a[128:131], a[132:135], v[208:223]
s_waitcnt lgkmcnt(15)
v_cvt_pk_bf16_f32 v197, v202, v203
v_sub_f32 v206, v206, v46
v_exp_f32 v206, v206
v_sub_f32 v207, v207, v46
v_exp_f32 v207, v207
v_mfma_f32_32x32x16_bf16 v[224:239], a[128:131], a[136:139], v[224:239]
v_add_f32 v42, v42, v204
v_add_f32 v42, v42, v205
v_cvt_pk_bf16_f32 v198, v204, v205
v_add_f32 v42, v42, v206
v_add_f32 v42, v42, v207
v_cvt_pk_bf16_f32 v199, v206, v207
v_sub_f32 v64, v64, v44
v_mfma_f32_32x32x16_bf16 v[240:255], a[128:131], a[140:143], v[240:255]
s_waitcnt lgkmcnt(12)
v_exp_f32 v64, v64
v_sub_f32 v65, v65, v44
v_exp_f32 v65, v65
v_sub_f32 v66, v66, v44
v_exp_f32 v66, v66
v_mfma_f32_32x32x16_bf16 v[208:223], a[144:147], a[148:151], v[208:223]
s_waitcnt lgkmcnt(11)
v_sub_f32 v67, v67, v44
v_exp_f32 v67, v67
v_add_f32 v40, v40, v64
v_add_f32 v40, v40, v65
v_cvt_pk_bf16_f32 v64, v64, v65
v_sub_f32 v68, v68, v44
v_mfma_f32_32x32x16_bf16 v[224:239], a[144:147], a[152:155], v[224:239]
s_waitcnt lgkmcnt(10)
v_exp_f32 v68, v68
v_sub_f32 v69, v69, v44
v_exp_f32 v69, v69
v_add_f32 v40, v40, v66
v_add_f32 v40, v40, v67
v_cvt_pk_bf16_f32 v65, v66, v67
v_mfma_f32_32x32x16_bf16 v[240:255], a[144:147], a[156:159], v[240:255]
s_waitcnt lgkmcnt(7)
v_sub_f32 v70, v70, v44
v_exp_f32 v70, v70
v_sub_f32 v71, v71, v44
v_exp_f32 v71, v71
v_add_f32 v40, v40, v68
v_add_f32 v40, v40, v69
v_mfma_f32_32x32x16_bf16 v[208:223], a[160:163], a[164:167], v[208:223]
s_waitcnt lgkmcnt(6)
v_cvt_pk_bf16_f32 v66, v68, v69
v_add_f32 v40, v40, v70
v_add_f32 v40, v40, v71
v_cvt_pk_bf16_f32 v67, v70, v71
v_sub_f32 v72, v72, v44
v_exp_f32 v72, v72
v_mfma_f32_32x32x16_bf16 v[224:239], a[160:163], a[168:171], v[224:239]
s_waitcnt lgkmcnt(5)
s_waitcnt lgkmcnt(0)
s_barrier
v_mfma_f32_32x32x16_bf16 v[240:255], a[160:163], a[172:175], v[240:255]
ds_read_b64_tr_b16 a[224:225], v31 offset:0
ds_read_b64_tr_b16 a[226:227], v31 offset:2048
ds_read_b64_tr_b16 a[240:241], v31 offset:4096
s_add_u32 m0, s54, 32768
s_nop 0
buffer_load_dwordx4 v13, s[24:27], s49 offen offset:0 lds
v_sub_f32 v73, v73, v44
v_mfma_f32_32x32x16_bf16 v[208:223], a[176:179], a[180:183], v[208:223]
ds_read_b64_tr_b16 a[242:243], v31 offset:6144
ds_read_b64_tr_b16 a[96:97], v32 offset:0
ds_read_b64_tr_b16 a[98:99], v32 offset:2048
v_exp_f32 v73, v73
v_sub_f32 v74, v74, v44
v_exp_f32 v74, v74
v_mfma_f32_32x32x16_bf16 v[224:239], a[176:179], a[184:187], v[224:239]
ds_read_b128 a[100:103], v28 offset:32768
ds_read_b128 a[104:107], v28 offset:33792
v_sub_f32 v75, v75, v44
v_exp_f32 v75, v75
v_add_f32 v40, v40, v72
v_add_f32 v40, v40, v73
v_mfma_f32_32x32x16_bf16 v[240:255], a[176:179], a[188:191], v[240:255]
s_waitcnt lgkmcnt(6)
ds_read_b128 a[108:111], v28 offset:34816
ds_read_b64_tr_b16 a[112:113], v32 offset:4096
ds_read_b64_tr_b16 a[114:115], v32 offset:6144
buffer_load_dwordx4 v13, s[24:27], s49 offen offset:1024 lds
v_cvt_pk_bf16_f32 v68, v72, v73
v_sub_f32 v76, v76, v44
v_mfma_f32_32x32x16_bf16 v[208:223], a[224:227], v[112:115], v[208:223]
ds_read_b128 a[116:119], v28 offset:35840
ds_read_b128 a[120:123], v28 offset:36864
v_exp_f32 v76, v76
v_sub_f32 v77, v77, v44
v_exp_f32 v77, v77
v_add_f32 v40, v40, v74
v_mfma_f32_32x32x16_bf16 v[224:239], a[224:227], v[128:131], v[224:239]
ds_read_b128 a[124:127], v28 offset:37888
ds_read_b64_tr_b16 a[128:129], v33 offset:0
ds_read_b64_tr_b16 a[130:131], v33 offset:2048
v_add_f32 v40, v40, v75
v_cvt_pk_bf16_f32 v69, v74, v75
v_sub_f32 v78, v78, v44
v_exp_f32 v78, v78
v_mfma_f32_32x32x16_bf16 v[240:255], a[224:227], v[144:147], v[240:255]
s_waitcnt lgkmcnt(12)
ds_read_b128 a[132:135], v29 offset:32768
ds_read_b128 a[136:139], v29 offset:33792
buffer_load_dwordx4 v13, s[24:27], s49 offen offset:2048 lds
v_sub_f32 v79, v79, v44
v_exp_f32 v79, v79
v_mfma_f32_32x32x16_bf16 v[208:223], a[240:243], v[116:119], v[208:223]
ds_read_b128 a[140:143], v29 offset:34816
ds_read_b64_tr_b16 a[144:145], v33 offset:4096
ds_read_b64_tr_b16 a[146:147], v33 offset:6144
v_add_f32 v40, v40, v76
v_add_f32 v40, v40, v77
v_cvt_pk_bf16_f32 v70, v76, v77
v_add_f32 v40, v40, v78
v_add_f32 v40, v40, v79
v_mfma_f32_32x32x16_bf16 v[224:239], a[240:243], v[132:135], v[224:239]
ds_read_b128 a[148:151], v29 offset:35840
ds_read_b128 a[152:155], v29 offset:36864
v_cvt_pk_bf16_f32 v71, v78, v79
v_sub_f32 v80, v80, v45
v_exp_f32 v80, v80
v_sub_f32 v81, v81, v45
v_mfma_f32_32x32x16_bf16 v[240:255], a[240:243], v[148:151], v[240:255]
s_waitcnt lgkmcnt(15)
ds_read_b128 a[156:159], v29 offset:37888
ds_read_b64_tr_b16 a[160:161], v34 offset:0
ds_read_b64_tr_b16 a[162:163], v34 offset:2048
buffer_load_dwordx4 v13, s[24:27], s49 offen offset:3072 lds
v_exp_f32 v81, v81
v_sub_f32 v82, v82, v45
v_mfma_f32_32x32x16_bf16 v[208:223], a[96:99], a[100:103], v[208:223]
ds_read_b128 a[164:167], v30 offset:32768
ds_read_b128 a[168:171], v30 offset:33792
v_exp_f32 v82, v82
v_sub_f32 v83, v83, v45
v_exp_f32 v83, v83
v_mfma_f32_32x32x16_bf16 v[224:239], a[96:99], a[104:107], v[224:239]
s_waitcnt lgkmcnt(15)
s_add_u32 m0, s54, 36864
ds_read_b128 a[172:175], v30 offset:34816
ds_read_b64_tr_b16 a[176:177], v34 offset:4096
ds_read_b64_tr_b16 a[178:179], v34 offset:6144
v_add_f32 v41, v41, v80
v_add_f32 v41, v41, v81
v_cvt_pk_bf16_f32 v80, v80, v81
v_sub_f32 v84, v84, v45
v_mfma_f32_32x32x16_bf16 v[240:255], a[96:99], a[108:111], v[240:255]
ds_read_b128 a[180:183], v30 offset:35840
ds_read_b128 a[184:187], v30 offset:36864
buffer_load_dwordx4 v13, s[24:27], s50 offen offset:0 lds
v_exp_f32 v84, v84
v_sub_f32 v85, v85, v45
v_mfma_f32_32x32x16_bf16 v[208:223], a[112:115], a[116:119], v[208:223]
ds_read_b128 a[188:191], v30 offset:37888
v_exp_f32 v85, v85
v_add_f32 v41, v41, v82
v_add_f32 v41, v41, v83
v_cvt_pk_bf16_f32 v81, v82, v83
v_sub_f32 v86, v86, v45
v_mfma_f32_32x32x16_bf16 v[224:239], a[112:115], a[120:123], v[224:239]
s_waitcnt lgkmcnt(15)
ds_write_b128 v27, v[160:163] offset:0
v_add_u32 v31, 0x8000, v31
v_add_u32 v32, 0x8000, v32
v_add_u32 v33, 0x8000, v33
v_mfma_f32_32x32x16_bf16 v[240:255], a[112:115], a[124:127], v[240:255]
buffer_load_dwordx4 v13, s[24:27], s50 offen offset:1024 lds
v_add_u32 v34, 0x8000, v34
v_exp_f32 v86, v86
v_sub_f32 v87, v87, v45
v_mfma_f32_32x32x16_bf16 v[208:223], a[128:131], a[132:135], v[208:223]
ds_write_b128 v27, v[164:167] offset:3072
v_exp_f32 v87, v87
v_add_f32 v41, v41, v84
v_add_f32 v41, v41, v85
v_mfma_f32_32x32x16_bf16 v[224:239], a[128:131], a[136:139], v[224:239]
v_cvt_pk_bf16_f32 v82, v84, v85
v_add_f32 v41, v41, v86
v_add_f32 v41, v41, v87
v_cvt_pk_bf16_f32 v83, v86, v87
v_sub_f32 v88, v88, v45
v_exp_f32 v88, v88
v_mfma_f32_32x32x16_bf16 v[240:255], a[128:131], a[140:143], v[240:255]
s_waitcnt lgkmcnt(14)
buffer_load_dwordx4 v13, s[24:27], s50 offen offset:2048 lds
v_sub_f32 v89, v89, v45
v_exp_f32 v89, v89
v_sub_f32 v90, v90, v45
v_exp_f32 v90, v90
v_mfma_f32_32x32x16_bf16 v[208:223], a[144:147], a[148:151], v[208:223]
s_waitcnt lgkmcnt(13)
ds_write_b128 v27, v[176:179] offset:1024
v_sub_f32 v91, v91, v45
v_mfma_f32_32x32x16_bf16 v[224:239], a[144:147], a[152:155], v[224:239]
s_waitcnt lgkmcnt(13)
ds_write_b128 v27, v[180:183] offset:4096
v_exp_f32 v91, v91
v_add_f32 v41, v41, v88
v_mfma_f32_32x32x16_bf16 v[240:255], a[144:147], a[156:159], v[240:255]
s_waitcnt lgkmcnt(11)
buffer_load_dwordx4 v13, s[24:27], s50 offen offset:3072 lds
ds_write_b128 v27, v[192:195] offset:2048
ds_write_b128 v27, v[196:199] offset:5120
v_mfma_f32_32x32x16_bf16 v[208:223], a[160:163], a[164:167], v[208:223]
s_waitcnt lgkmcnt(12)
v_add_f32 v41, v41, v89
v_cvt_pk_bf16_f32 v84, v88, v89
v_sub_f32 v92, v92, v45
v_exp_f32 v92, v92
v_sub_f32 v93, v93, v45
v_exp_f32 v93, v93
v_mfma_f32_32x32x16_bf16 v[224:239], a[160:163], a[168:171], v[224:239]
s_waitcnt lgkmcnt(11)
s_waitcnt lgkmcnt(0)
s_barrier
v_mfma_f32_32x32x16_bf16 v[240:255], a[160:163], a[172:175], v[240:255]
ds_read_b64_tr_b16 a[224:225], v31 offset:32768
ds_read_b64_tr_b16 a[226:227], v31 offset:34816
ds_read_b64_tr_b16 a[240:241], v31 offset:36864
s_add_u32 m0, s54, 0
s_nop 0
buffer_load_dwordx4 v1, s[96:99], s83 offen offset:0 lds
v_add_f32 v41, v41, v90
v_mfma_f32_32x32x16_bf16 v[208:223], a[176:179], a[180:183], v[208:223]
ds_read_b64_tr_b16 a[242:243], v31 offset:38912
ds_read_b64_tr_b16 a[96:97], v32 offset:32768
ds_read_b64_tr_b16 a[98:99], v32 offset:34816
v_add_f32 v41, v41, v91
v_cvt_pk_bf16_f32 v85, v90, v91
v_sub_f32 v94, v94, v45
v_exp_f32 v94, v94
v_mfma_f32_32x32x16_bf16 v[224:239], a[176:179], a[184:187], v[224:239]
ds_read_b128 a[100:103], v28 offset:0
ds_read_b128 a[104:107], v28 offset:1024
v_sub_f32 v95, v95, v45
v_exp_f32 v95, v95
v_add_f32 v41, v41, v92
v_add_f32 v41, v41, v93
v_mfma_f32_32x32x16_bf16 v[240:255], a[176:179], a[188:191], v[240:255]
s_waitcnt lgkmcnt(6)
ds_read_b128 a[108:111], v28 offset:2048
ds_read_b64_tr_b16 a[112:113], v32 offset:36864
ds_read_b64_tr_b16 a[114:115], v32 offset:38912
buffer_load_dwordx4 v2, s[96:99], s83 offen offset:1024 lds
v_cvt_pk_bf16_f32 v86, v92, v93
v_add_f32 v41, v41, v94
v_add_f32 v41, v41, v95
v_mfma_f32_32x32x16_bf16 v[208:223], a[224:227], v[160:163], v[208:223]
ds_read_b128 a[116:119], v28 offset:3072
ds_read_b128 a[120:123], v28 offset:4096
v_cvt_pk_bf16_f32 v87, v94, v95
v_sub_f32 v96, v96, v46
v_exp_f32 v96, v96
v_sub_f32 v97, v97, v46
v_mfma_f32_32x32x16_bf16 v[224:239], a[224:227], v[176:179], v[224:239]
s_add_u32 s57, s83, 36864
ds_read_b128 a[124:127], v28 offset:5120
ds_read_b64_tr_b16 a[128:129], v33 offset:32768
ds_read_b64_tr_b16 a[130:131], v33 offset:34816
v_exp_f32 v97, v97
v_sub_f32 v98, v98, v46
v_mfma_f32_32x32x16_bf16 v[240:255], a[224:227], v[192:195], v[240:255]
s_waitcnt lgkmcnt(12)
ds_read_b128 a[132:135], v29 offset:0
ds_read_b128 a[136:139], v29 offset:1024
buffer_load_dwordx4 v3, s[96:99], s83 offen offset:2048 lds
v_exp_f32 v98, v98
v_sub_f32 v99, v99, v46
v_mfma_f32_32x32x16_bf16 v[208:223], a[240:243], v[164:167], v[208:223]
ds_read_b128 a[140:143], v29 offset:2048
ds_read_b64_tr_b16 a[144:145], v33 offset:36864
ds_read_b64_tr_b16 a[146:147], v33 offset:38912
v_exp_f32 v99, v99
v_add_f32 v42, v42, v96
v_add_f32 v42, v42, v97
v_cvt_pk_bf16_f32 v96, v96, v97
v_sub_f32 v100, v100, v46
v_mfma_f32_32x32x16_bf16 v[224:239], a[240:243], v[180:183], v[224:239]
ds_read_b128 a[148:151], v29 offset:3072
ds_read_b128 a[152:155], v29 offset:4096
v_exp_f32 v100, v100
v_sub_f32 v101, v101, v46
v_exp_f32 v101, v101
v_mfma_f32_32x32x16_bf16 v[240:255], a[240:243], v[196:199], v[240:255]
s_waitcnt lgkmcnt(15)
ds_read_b128 a[156:159], v29 offset:5120
ds_read_b64_tr_b16 a[160:161], v34 offset:32768
ds_read_b64_tr_b16 a[162:163], v34 offset:34816
buffer_load_dwordx4 v4, s[96:99], s83 offen offset:3072 lds
v_add_f32 v42, v42, v98
v_add_f32 v42, v42, v99
v_cvt_pk_bf16_f32 v97, v98, v99
v_mfma_f32_32x32x16_bf16 v[208:223], a[96:99], a[100:103], v[208:223]
ds_read_b128 a[164:167], v30 offset:0
ds_read_b128 a[168:171], v30 offset:1024
v_sub_f32 v102, v102, v46
v_exp_f32 v102, v102
v_sub_f32 v103, v103, v46
v_mfma_f32_32x32x16_bf16 v[224:239], a[96:99], a[104:107], v[224:239]
s_waitcnt lgkmcnt(15)
s_add_u32 m0, s54, 4096
ds_read_b128 a[172:175], v30 offset:2048
ds_read_b64_tr_b16 a[176:177], v34 offset:36864
ds_read_b64_tr_b16 a[178:179], v34 offset:38912
v_exp_f32 v103, v103
v_add_f32 v42, v42, v100
v_add_f32 v42, v42, v101
v_cvt_pk_bf16_f32 v98, v100, v101
v_mfma_f32_32x32x16_bf16 v[240:255], a[96:99], a[108:111], v[240:255]
ds_read_b128 a[180:183], v30 offset:3072
ds_read_b128 a[184:187], v30 offset:4096
buffer_load_dwordx4 v1, s[96:99], s57 offen offset:0 lds
v_add_f32 v42, v42, v102
v_add_f32 v42, v42, v103
v_cvt_pk_bf16_f32 v99, v102, v103
v_mfma_f32_32x32x16_bf16 v[208:223], a[112:115], a[116:119], v[208:223]
ds_read_b128 a[188:191], v30 offset:5120
v_sub_f32 v104, v104, v46
v_exp_f32 v104, v104
v_sub_f32 v105, v105, v46
v_exp_f32 v105, v105
v_sub_f32 v106, v106, v46
v_mfma_f32_32x32x16_bf16 v[224:239], a[112:115], a[120:123], v[224:239]
s_waitcnt lgkmcnt(15)
ds_write_b128 v27, v[64:67] offset:32768
v_exp_f32 v106, v106
v_mfma_f32_32x32x16_bf16 v[240:255], a[112:115], a[124:127], v[240:255]
buffer_load_dwordx4 v2, s[96:99], s57 offen offset:1024 lds
v_sub_f32 v107, v107, v46
v_exp_f32 v107, v107
v_add_f32 v42, v42, v104
v_add_f32 v42, v42, v105
v_mfma_f32_32x32x16_bf16 v[208:223], a[128:131], a[132:135], v[208:223]
ds_write_b128 v27, v[68:71] offset:35840
v_cvt_pk_bf16_f32 v100, v104, v105
v_sub_f32 v108, v108, v46
v_mfma_f32_32x32x16_bf16 v[224:239], a[128:131], a[136:139], v[224:239]
ds_write_b128 v27, v[80:83] offset:33792
v_exp_f32 v108, v108
v_sub_f32 v109, v109, v46
v_mfma_f32_32x32x16_bf16 v[240:255], a[128:131], a[140:143], v[240:255]
s_waitcnt lgkmcnt(15)
buffer_load_dwordx4 v3, s[96:99], s57 offen offset:2048 lds
v_exp_f32 v109, v109
v_add_f32 v42, v42, v106
v_add_f32 v42, v42, v107
v_cvt_pk_bf16_f32 v101, v106, v107
v_mfma_f32_32x32x16_bf16 v[208:223], a[144:147], a[148:151], v[208:223]
s_waitcnt lgkmcnt(14)
ds_write_b128 v27, v[84:87] offset:36864
v_sub_f32 v110, v110, v46
v_exp_f32 v110, v110
v_mfma_f32_32x32x16_bf16 v[224:239], a[144:147], a[152:155], v[224:239]
s_waitcnt lgkmcnt(14)
ds_write_b128 v27, v[96:99] offset:34816
v_sub_f32 v111, v111, v46
v_mfma_f32_32x32x16_bf16 v[240:255], a[144:147], a[156:159], v[240:255]
s_waitcnt lgkmcnt(12)
buffer_load_dwordx4 v4, s[96:99], s57 offen offset:3072 lds
v_exp_f32 v111, v111
v_add_f32 v42, v42, v108
v_add_f32 v42, v42, v109
v_cvt_pk_bf16_f32 v102, v108, v109
v_add_f32 v42, v42, v110
v_add_f32 v42, v42, v111
v_cvt_pk_bf16_f32 v103, v110, v111
v_mov_b32 v48, v40
v_mov_b32 v49, v41
v_mov_b32 v50, v42
v_permlane32_swap_b32 v48, v40
v_permlane32_swap_b32 v49, v41
v_permlane32_swap_b32 v50, v42
v_add_f32 v40, v40, v48
v_add_f32 v41, v41, v49
v_add_f32 v42, v42, v50
ds_write_b128 v27, v[100:103] offset:37888
ds_write_b128 v27, v[40:43] offset:38912
v_mfma_f32_32x32x16_bf16 v[208:223], a[160:163], a[164:167], v[208:223]
s_waitcnt lgkmcnt(13)
v_mfma_f32_32x32x16_bf16 v[224:239], a[160:163], a[168:171], v[224:239]
s_waitcnt lgkmcnt(12)
s_waitcnt vmcnt(8) lgkmcnt(0)
s_barrier
v_mfma_f32_32x32x16_bf16 v[240:255], a[160:163], a[172:175], v[240:255]
ds_read_b64_tr_b16 a[224:225], v31 offset:0
ds_read_b64_tr_b16 a[226:227], v31 offset:2048
ds_read_b64_tr_b16 a[240:241], v31 offset:4096
s_add_u32 m0, s54, 65536
s_nop 0
buffer_load_dwordx4 v1, s[96:99], s84 offen offset:0 lds
v_mfma_f32_32x32x16_bf16 v[208:223], a[176:179], a[180:183], v[208:223]
ds_read_b64_tr_b16 a[242:243], v31 offset:6144
ds_read_b64_tr_b16 a[96:97], v32 offset:0
ds_read_b64_tr_b16 a[98:99], v32 offset:2048
v_mfma_f32_32x32x16_bf16 v[224:239], a[176:179], a[184:187], v[224:239]
ds_read_b128 a[100:103], v28 offset:32768
ds_read_b128 a[104:107], v28 offset:33792
buffer_load_dwordx4 v2, s[96:99], s84 offen offset:1024 lds
v_mfma_f32_32x32x16_bf16 v[240:255], a[176:179], a[188:191], v[240:255]
s_waitcnt lgkmcnt(6)
s_add_u32 s57, s84, 36864
ds_read_b128 a[108:111], v28 offset:34816
ds_read_b64_tr_b16 a[112:113], v32 offset:4096
ds_read_b64_tr_b16 a[114:115], v32 offset:6144
v_mfma_f32_32x32x16_bf16 v[208:223], a[224:227], v[64:67], v[208:223]
ds_read_b128 a[116:119], v28 offset:35840
ds_read_b128 v[48:51], v26 offset:38912
buffer_load_dwordx4 v3, s[96:99], s84 offen offset:2048 lds
v_mfma_f32_32x32x16_bf16 v[224:239], a[224:227], v[80:83], v[224:239]
ds_read_b128 v[52:55], v26 offset:47104
ds_read_b128 v[56:59], v26 offset:55296
v_mfma_f32_32x32x16_bf16 v[240:255], a[224:227], v[96:99], v[240:255]
s_waitcnt lgkmcnt(11)
ds_read_b128 v[60:63], v26 offset:63488
ds_read_b64_tr_b16 a[128:129], v33 offset:0
ds_read_b64_tr_b16 a[130:131], v33 offset:2048
buffer_load_dwordx4 v4, s[96:99], s84 offen offset:3072 lds
v_mfma_f32_32x32x16_bf16 v[208:223], a[240:243], v[68:71], v[208:223]
s_add_u32 m0, s54, 69632
ds_read_b128 a[132:135], v29 offset:32768
ds_read_b64_tr_b16 a[144:145], v33 offset:4096
ds_read_b64_tr_b16 a[146:147], v33 offset:6144
v_mfma_f32_32x32x16_bf16 v[224:239], a[240:243], v[84:87], v[224:239]
ds_read_b128 a[148:151], v29 offset:35840
ds_read_b64_tr_b16 a[160:161], v34 offset:0
ds_read_b64_tr_b16 a[162:163], v34 offset:2048
buffer_load_dwordx4 v1, s[96:99], s57 offen offset:0 lds
v_mfma_f32_32x32x16_bf16 v[240:255], a[240:243], v[100:103], v[240:255]
s_waitcnt lgkmcnt(15)
ds_read_b128 a[164:167], v30 offset:32768
ds_read_b64_tr_b16 a[176:177], v34 offset:4096
ds_read_b64_tr_b16 a[178:179], v34 offset:6144
v_mfma_f32_32x32x16_bf16 v[208:223], a[96:99], a[100:103], v[208:223]
ds_read_b128 a[180:183], v30 offset:35840
ds_read_b128 a[120:123], v28 offset:36864
buffer_load_dwordx4 v2, s[96:99], s57 offen offset:1024 lds
v_mfma_f32_32x32x16_bf16 v[224:239], a[96:99], a[104:107], v[224:239]
ds_read_b128 a[136:139], v29 offset:33792
ds_read_b128 a[152:155], v29 offset:36864
v_mfma_f32_32x32x16_bf16 v[240:255], a[96:99], a[108:111], v[240:255]
s_waitcnt lgkmcnt(15)
ds_read_b128 a[168:171], v30 offset:33792
ds_read_b128 a[184:187], v30 offset:36864
buffer_load_dwordx4 v3, s[96:99], s57 offen offset:2048 lds
v_mfma_f32_32x32x16_bf16 v[208:223], a[112:115], a[116:119], v[208:223]
s_waitcnt lgkmcnt(14)
ds_read_b128 a[124:127], v28 offset:37888
ds_read_b128 a[140:143], v29 offset:34816
v_add_f32 v40, v48, v52
v_add_f32 v41, v49, v53
v_add_f32 v42, v50, v54
v_add_f32 v48, v56, v60
v_add_f32 v49, v57, v61
v_mfma_f32_32x32x16_bf16 v[208:223], a[128:131], a[132:135], v[208:223]
s_waitcnt lgkmcnt(13)
ds_read_b128 a[156:159], v29 offset:37888
ds_read_b128 a[172:175], v30 offset:34816
buffer_load_dwordx4 v4, s[96:99], s57 offen offset:3072 lds
v_add_f32 v50, v58, v62
v_add_f32 v40, v40, v48
v_add_f32 v41, v41, v49
v_add_f32 v42, v42, v50
v_mfma_f32_32x32x16_bf16 v[208:223], a[144:147], a[148:151], v[208:223]
s_waitcnt lgkmcnt(12)
s_add_u32 m0, s54, 98304
ds_read_b128 a[188:191], v30 offset:37888
v_rcp_f32 v40, v40
v_rcp_f32 v41, v41
v_mfma_f32_32x32x16_bf16 v[208:223], a[160:163], a[164:167], v[208:223]
s_waitcnt lgkmcnt(10)
buffer_load_dwordx4 v1, s[96:99], s85 offen offset:0 lds
v_rcp_f32 v42, v42
v_mfma_f32_32x32x16_bf16 v[208:223], a[176:179], a[180:183], v[208:223]
s_waitcnt lgkmcnt(9)
v_mfma_f32_32x32x16_bf16 v[224:239], a[112:115], a[120:123], v[224:239]
s_waitcnt lgkmcnt(8)
s_waitcnt vmcnt(9) lgkmcnt(0)
s_barrier
v_mfma_f32_32x32x16_bf16 v[224:239], a[128:131], a[136:139], v[224:239]
ds_read_b64_tr_b16 v[64:65], v5 offset:0
ds_read_b64_tr_b16 v[66:67], v5 offset:1024
ds_read_b64_tr_b16 v[68:69], v5 offset:4096
buffer_load_dwordx4 v2, s[96:99], s85 offen offset:1024 lds
s_nop 1
v_mul_f32 v208, v208, v40
v_mul_f32 v209, v209, v40
v_mfma_f32_32x32x16_bf16 v[224:239], a[144:147], a[152:155], v[224:239]
s_add_u32 s57, s85, 36864
ds_read_b64_tr_b16 v[70:71], v5 offset:5120
ds_read_b64_tr_b16 v[72:73], v5 offset:8192
ds_read_b64_tr_b16 v[74:75], v5 offset:9216
v_mul_f32 v210, v210, v40
v_mul_f32 v211, v211, v40
v_mul_f32 v212, v212, v40
v_mul_f32 v213, v213, v40
v_mfma_f32_32x32x16_bf16 v[224:239], a[160:163], a[168:171], v[224:239]
ds_read_b64_tr_b16 v[76:77], v5 offset:12288
ds_read_b64_tr_b16 v[78:79], v5 offset:13312
ds_read_b64_tr_b16 v[80:81], v5 offset:16384
buffer_load_dwordx4 v3, s[96:99], s85 offen offset:2048 lds
v_mul_f32 v214, v214, v40
v_mul_f32 v215, v215, v40
v_mfma_f32_32x32x16_bf16 v[224:239], a[176:179], a[184:187], v[224:239]
ds_read_b64_tr_b16 v[82:83], v5 offset:17408
ds_read_b64_tr_b16 v[84:85], v5 offset:20480
ds_read_b64_tr_b16 v[86:87], v5 offset:21504
v_cvt_pk_bf16_f32 v208, v208, v209
v_cvt_pk_bf16_f32 v209, v210, v211
v_cvt_pk_bf16_f32 v210, v212, v213
v_cvt_pk_bf16_f32 v211, v214, v215
v_mul_f32 v216, v216, v40
v_mfma_f32_32x32x16_bf16 v[240:255], a[112:115], a[124:127], v[240:255]
ds_read_b64_tr_b16 v[88:89], v5 offset:24576
ds_read_b64_tr_b16 v[90:91], v5 offset:25600
ds_read_b64_tr_b16 v[92:93], v5 offset:28672
buffer_load_dwordx4 v4, s[96:99], s85 offen offset:3072 lds
v_mul_f32 v217, v217, v40
v_mul_f32 v218, v218, v40
v_mfma_f32_32x32x16_bf16 v[240:255], a[128:131], a[140:143], v[240:255]
s_add_u32 m0, s54, 102400
ds_read_b64_tr_b16 v[94:95], v5 offset:29696
v_mul_f32 v219, v219, v40
v_mul_f32 v220, v220, v40
v_mul_f32 v221, v221, v40
v_mul_f32 v222, v222, v40
v_mul_f32 v223, v223, v40
v_cvt_pk_bf16_f32 v212, v216, v217
v_mfma_f32_32x32x16_bf16 v[240:255], a[144:147], a[156:159], v[240:255]
buffer_load_dwordx4 v1, s[96:99], s57 offen offset:0 lds
v_cvt_pk_bf16_f32 v213, v218, v219
v_cvt_pk_bf16_f32 v214, v220, v221
v_cvt_pk_bf16_f32 v215, v222, v223
v_mul_f32 v224, v224, v41
v_mul_f32 v225, v225, v41
v_mfma_f32_32x32x16_bf16 v[240:255], a[160:163], a[172:175], v[240:255]
ds_write_b128 v8, v[208:211] offset:0
v_mul_f32 v226, v226, v41
v_mul_f32 v227, v227, v41
v_mfma_f32_32x32x16_bf16 v[240:255], a[176:179], a[188:191], v[240:255]
buffer_load_dwordx4 v2, s[96:99], s57 offen offset:1024 lds
v_mul_f32 v228, v228, v41
v_mul_f32 v229, v229, v41
v_mul_f32 v230, v230, v41
v_mul_f32 v231, v231, v41
v_cvt_pk_bf16_f32 v224, v224, v225
v_cvt_pk_bf16_f32 v225, v226, v227
ds_write_b128 v8, v[212:215] offset:512
v_cvt_pk_bf16_f32 v226, v228, v229
v_cvt_pk_bf16_f32 v227, v230, v231
ds_write_b128 v8, v[224:227] offset:2048
v_mul_f32 v232, v232, v41
v_mul_f32 v233, v233, v41
v_mul_f32 v234, v234, v41
v_mul_f32 v235, v235, v41
v_mul_f32 v236, v236, v41
v_mul_f32 v237, v237, v41
v_mul_f32 v238, v238, v41
v_mul_f32 v239, v239, v41
v_cvt_pk_bf16_f32 v228, v232, v233
v_cvt_pk_bf16_f32 v229, v234, v235
v_cvt_pk_bf16_f32 v230, v236, v237
v_cvt_pk_bf16_f32 v231, v238, v239
ds_write_b128 v8, v[228:231] offset:2560
v_pk_mul_f32 v[240:241], v[240:241], v[42:43] op_sel:[0,0] op_sel_hi:[1,0]
v_pk_mul_f32 v[242:243], v[242:243], v[42:43] op_sel:[0,0] op_sel_hi:[1,0]
v_pk_mul_f32 v[244:245], v[244:245], v[42:43] op_sel:[0,0] op_sel_hi:[1,0]
v_pk_mul_f32 v[246:247], v[246:247], v[42:43] op_sel:[0,0] op_sel_hi:[1,0]
v_cvt_pk_bf16_f32 v240, v240, v241
v_cvt_pk_bf16_f32 v241, v242, v243
v_cvt_pk_bf16_f32 v242, v244, v245
v_cvt_pk_bf16_f32 v243, v246, v247
ds_write_b128 v8, v[240:243] offset:4096
buffer_load_dwordx4 v3, s[96:99], s57 offen offset:2048 lds
buffer_load_dwordx4 v4, s[96:99], s57 offen offset:3072 lds
v_pk_mul_f32 v[248:249], v[248:249], v[42:43] op_sel:[0,0] op_sel_hi:[1,0]
v_pk_mul_f32 v[250:251], v[250:251], v[42:43] op_sel:[0,0] op_sel_hi:[1,0]
v_pk_mul_f32 v[252:253], v[252:253], v[42:43] op_sel:[0,0] op_sel_hi:[1,0]
v_pk_mul_f32 v[254:255], v[254:255], v[42:43] op_sel:[0,0] op_sel_hi:[1,0]
v_cvt_pk_bf16_f32 v244, v248, v249
v_cvt_pk_bf16_f32 v245, v250, v251
v_cvt_pk_bf16_f32 v246, v252, v253
v_cvt_pk_bf16_f32 v247, v254, v255
ds_write_b128 v8, v[244:247] offset:4608
s_add_u32 m0, s54, 32768
s_nop 0
buffer_load_dwordx4 v1, s[96:99], s86 offen offset:0 lds
buffer_load_dwordx4 v2, s[96:99], s86 offen offset:1024 lds
s_add_u32 s57, s86, 36864
buffer_load_dwordx4 v3, s[96:99], s86 offen offset:2048 lds
buffer_load_dwordx4 v4, s[96:99], s86 offen offset:3072 lds
s_add_u32 m0, s54, 36864
s_nop 0
buffer_load_dwordx4 v1, s[96:99], s57 offen offset:0 lds
buffer_load_dwordx4 v2, s[96:99], s57 offen offset:1024 lds
buffer_load_dwordx4 v3, s[96:99], s57 offen offset:2048 lds
buffer_load_dwordx4 v4, s[96:99], s57 offen offset:3072 lds
s_nop 15
s_waitcnt vmcnt(0) lgkmcnt(0)
s_branch K1_EPI
.section .rodata,"a"
.p2align 6
.amdhsa_kernel standalone__gqa_block_cached__near_ridge_kernel
  .amdhsa_next_free_vgpr 512
  .amdhsa_next_free_sgpr 102
  .amdhsa_accum_offset 256
  .amdhsa_group_segment_fixed_size 0
  .amdhsa_kernarg_size 64
  .amdhsa_user_sgpr_count 2
  .amdhsa_user_sgpr_kernarg_segment_ptr 1
  .amdhsa_system_sgpr_workgroup_id_x 1
.end_amdhsa_kernel
```
